```python
import torch

def _softmax(x, axis=-1):
    return torch.softmax(x, dim=axis)
def _gelu(x):
    return torch.nn.functional.gelu(x, approximate="tanh")
def _silu(x):
    return torch.nn.functional.silu(x)
def _sigmoid(x):
    return torch.sigmoid(x)
def _layernorm(x, axis=-1, eps=1e-5):
    m = x.mean(dim=axis, keepdim=True)
    v = x.var(dim=axis, keepdim=True, unbiased=False)
    return (x - m) / torch.sqrt(v + eps)
def _scatter_add(tgt, idx, src, axis=0):
    return tgt.clone().index_add_(axis, idx, src)
def _segment_sum(src, seg, n):
    out = torch.zeros((n,) + src.shape[1:], dtype=src.dtype)
    return out.index_add_(0, seg, src)
def _pad(x, pw):
    flat = tuple(v for pair in reversed(pw) for v in pair)
    return torch.nn.functional.pad(x, flat)

kernel_name = 'gated_mix__mha_block_cached__dense_activation_squared_relu__decode'

def setup_inputs():

    _w = (lambda a: (lambda t: t.to(torch.bfloat16) if t.is_floating_point() else t)(torch.as_tensor(a)))
    def _A_setup():
        B, Sq, D = 4, 1, 512
        H, Sk, Dh = 32, 8192, 128
        return {
            "x": _w((lambda *s: torch.randn(*s, dtype=torch.bfloat16) * 0.05)(B, Sq, D)),
            "k_cache": _w((lambda *s: torch.randn(*s, dtype=torch.bfloat16) * 6.4)(B, H, Sk, Dh)),
            "v_cache": _w((lambda *s: torch.randn(*s, dtype=torch.bfloat16) * 0.4)(B, H, Sk, Dh)),
            "wq": _w((lambda *s: torch.randn(*s, dtype=torch.bfloat16) * 6.4)(D, H * Dh) * (D ** -0.5)),
            "wo": _w((lambda *s: torch.randn(*s, dtype=torch.bfloat16) * 0.4)(H * Dh, D) * ((H * Dh) ** -0.5)),
        }
    _A_in = _A_setup()

    def _B_setup():
        B, S, D, F = 4, 1, 512, 1792
        return {
            "x": _w((lambda *s: torch.randn(*s, dtype=torch.bfloat16) * 0.05)(B, S, D)),
            "w1": _w((lambda *s: torch.randn(*s, dtype=torch.bfloat16) * 0.05)(D, F)),
            "b1": _w((lambda *s: torch.randn(*s, dtype=torch.bfloat16) * 0.05)(F)),
            "w2": _w((lambda *s: torch.randn(*s, dtype=torch.bfloat16) * 0.05)(F, D)),
            "b2": _w((lambda *s: torch.randn(*s, dtype=torch.bfloat16) * 0.05)(D)),
        }
    _B_in = _B_setup()

    return {
        "A_x": _A_in["x"],
        "A_k_cache": _A_in["k_cache"],
        "A_v_cache": _A_in["v_cache"],
        "A_wq": _A_in["wq"],
        "A_wo": _A_in["wo"],
        "B_x": _B_in["x"],
        "B_w1": _B_in["w1"],
        "B_b1": _B_in["b1"],
        "B_w2": _B_in["w2"],
        "B_b2": _B_in["b2"],
        "gate_w": _w((lambda *s: torch.randn(*s, dtype=torch.bfloat16) * 0.05)(512) * 16.0),
    }

def reference(A_x, A_k_cache, A_v_cache, A_wq, A_wo, B_x, B_w1, B_b1, B_w2, B_b2, gate_w):
    def _A_ref(x, k_cache, v_cache, wq, wo):
        B, Sq, D = x.shape
        H, Dh = 32, 128
        q = (lambda x, *d: x.permute(*d))((x @ wq).reshape(B, Sq, H, Dh), 0, 2, 1, 3)
        scores = torch.einsum("bhqd,bhkd->bhqk", q, k_cache) * (Dh ** -0.5)
        p = _softmax(scores, axis=-1)
        o = torch.einsum("bhqk,bhkd->bhqd", p, v_cache)
        return (lambda x, *d: x.permute(*d))(o, 0, 2, 1, 3).reshape(B, Sq, H * Dh) @ wo

    def _B_ref(x, w1, b1, w2, b2):
        h = torch.einsum("bsd,df->bsf", x, w1) + b1
        zero = torch.zeros_like(h)
        r = torch.where(h > zero, h, zero)
        h = r * r
        out = torch.einsum("bsf,fd->bsd", h, w2) + b2
        return out

    x = A_x
    g = _sigmoid((x * gate_w).sum(-1, keepdims=True))
    a = _A_ref(x, A_k_cache, A_v_cache, A_wq, A_wo)
    b = _B_ref(x, B_w1, B_b1, B_w2, B_b2)
    return g * a + (1 - g) * b
```

```asm
; @launch kernel=gated_mix__mha_block_cached__dense_activation_squared_relu__decode_kernel grid=(256,1,1) block=(512,1,1) lds=25856
; @launch kernel=final_reduce_kernel grid=(64,1,1) block=(64,1,1) lds=0
.amdgcn_target "amdgcn-amd-amdhsa--gfx950"
.text
.globl gated_mix__mha_block_cached__dense_activation_squared_relu__decode_kernel
.p2align 8
.type gated_mix__mha_block_cached__dense_activation_squared_relu__decode_kernel,@function
gated_mix__mha_block_cached__dense_activation_squared_relu__decode_kernel:
    s_cmp_ge_u32 s2, 256
    s_cbranch_scc1 L_done
    s_load_dwordx16 s[4:19], s[0:1], 0
    s_load_dwordx8 s[20:27], s[0:1], 64
    s_load_dwordx4 s[28:31], s[0:1], 96
    v_lshrrev_b32 v11, 6, v0
    v_and_b32 v1, 63, v0
    v_readfirstlane_b32 s3, v11
    v_lshrrev_b32 v2, 4, v1
    v_and_b32 v3, 15, v1
    s_and_b32 s60, s2, 7
    s_lshr_b32 s61, s2, 3
    s_and_b32 s62, s61, 3
    s_lshl_b32 s32, s60, 2
    s_add_u32 s32, s32, s62
    s_lshr_b32 s35, s61, 2
    s_lshr_b32 s33, s61, 3
    s_and_b32 s34, s35, 1
    s_add_u32 s63, s3, s35
    s_and_b32 s63, s63, 7
    s_lshl_b32 s64, s63, 6
    v_lshl_add_u32 v40, v2, 2, s64
    v_lshlrev_b32 v44, 13, v40
    v_lshl_add_u32 v44, v3, 4, v44
    v_lshlrev_b32 v11, 1, v40
    s_lshl_b32 s65, s32, 8
    s_lshl_b32 s66, s33, 10
    s_mov_b32 s68, 0
    s_waitcnt lgkmcnt(0)
    s_add_u32 s52, s10, s65
    s_addc_u32 s53, s11, 0
    s_sub_u32 s54, 0x400000, s65
    s_mov_b32 s55, 0x20000
    s_mov_b32 s78, s4
    s_mov_b32 s79, s5
    s_add_u32 s4, s4, s66
    s_addc_u32 s5, s5, 0
    global_load_dwordx2 v[52:53], v11, s[4:5] offset:0
    global_load_dwordx2 v[54:55], v11, s[4:5] offset:32
    global_load_dwordx2 v[56:57], v11, s[4:5] offset:64
    global_load_dwordx2 v[58:59], v11, s[4:5] offset:96
    s_cmp_lg_u32 s3, 0
    s_cbranch_scc1 L_notouch
    s_lshl_b32 s69, s35, 6
    v_add_u32 v112, s69, v1
    v_lshlrev_b32 v112, 13, v112
    buffer_load_dword v113, v112, s[52:55], 0 offen
    buffer_load_dword v114, v112, s[52:55], 0 offen offset:128
L_notouch:
    v_lshlrev_b32 v4, 8, v3
    v_lshl_add_u32 v4, v2, 4, v4
    v_lshlrev_b32 v5, 10, v2
    v_lshl_add_u32 v5, v3, 4, v5
    s_lshl_b32 s36, s33, 5
    s_add_u32 s36, s36, s32
    s_lshl_b32 s36, s36, 1
    s_add_u32 s36, s36, s34
    s_lshl_b32 s63, s36, 20
    s_add_u32 s44, s6, s63
    s_addc_u32 s45, s7, 0
    s_mov_b32 s46, 0x100000
    s_mov_b32 s47, 0x20000
    s_add_u32 s48, s8, s63
    s_addc_u32 s49, s9, 0
    s_mov_b32 s50, 0x100000
    s_mov_b32 s51, 0x20000
    s_lshl_b32 s97, s35, 2
    s_lshr_b32 s97, 0x10101010, s97
    s_and_b32 s97, s97, 15
    s_cmp_ge_u32 s3, 4
    s_cselect_b32 s97, 0, s97
    s_cmp_le_u32 s97, 0
    s_cbranch_scc1 L_pre0
    s_lshl_b32 s37, s3, 12
    buffer_load_dwordx4 v[64:67], v4, s[44:47], s37 offen offset:0 nt
    buffer_load_dwordx4 v[68:71], v4, s[44:47], s37 offen offset:64 nt
    buffer_load_dwordx4 v[72:75], v4, s[44:47], s37 offen offset:128 nt
    buffer_load_dwordx4 v[76:79], v4, s[44:47], s37 offen offset:192 nt
    buffer_load_dwordx4 v[80:83], v5, s[48:51], s37 offen offset:0 nt
    buffer_load_dwordx4 v[84:87], v5, s[48:51], s37 offen offset:256 nt
    buffer_load_dwordx4 v[88:91], v5, s[48:51], s37 offen offset:512 nt
    buffer_load_dwordx4 v[92:95], v5, s[48:51], s37 offen offset:768 nt
    s_add_u32 s37, s37, 32768
L_pre0:
    buffer_load_dwordx4 v[128:131], v44, s[52:55], s68 offen
    s_add_u32 s68, s68, 8192
    buffer_load_dwordx4 v[132:135], v44, s[52:55], s68 offen
    s_add_u32 s68, s68, 8192
    buffer_load_dwordx4 v[136:139], v44, s[52:55], s68 offen
    s_add_u32 s68, s68, 8192
    buffer_load_dwordx4 v[140:143], v44, s[52:55], s68 offen
    s_add_u32 s68, s68, 106496
    buffer_load_dwordx4 v[144:147], v44, s[52:55], s68 offen
    s_add_u32 s68, s68, 8192
    buffer_load_dwordx4 v[148:151], v44, s[52:55], s68 offen
    s_add_u32 s68, s68, 8192
    buffer_load_dwordx4 v[152:155], v44, s[52:55], s68 offen
    s_add_u32 s68, s68, 8192
    buffer_load_dwordx4 v[156:159], v44, s[52:55], s68 offen
    s_add_u32 s68, s68, 106496
    buffer_load_dwordx4 v[160:163], v44, s[52:55], s68 offen
    s_add_u32 s68, s68, 8192
    buffer_load_dwordx4 v[164:167], v44, s[52:55], s68 offen
    s_add_u32 s68, s68, 8192
    buffer_load_dwordx4 v[168:171], v44, s[52:55], s68 offen
    s_add_u32 s68, s68, 8192
    buffer_load_dwordx4 v[172:175], v44, s[52:55], s68 offen
    s_add_u32 s68, s68, 106496
    buffer_load_dwordx4 v[176:179], v44, s[52:55], s68 offen
    s_add_u32 s68, s68, 8192
    buffer_load_dwordx4 v[180:183], v44, s[52:55], s68 offen
    s_add_u32 s68, s68, 8192
    buffer_load_dwordx4 v[184:187], v44, s[52:55], s68 offen
    s_add_u32 s68, s68, 8192
    buffer_load_dwordx4 v[188:191], v44, s[52:55], s68 offen
    s_barrier
    s_cmp_ge_u32 s3, 4
    s_cbranch_scc1 L_pf1
    s_cmp_gt_u32 s97, 0
    s_cbranch_scc1 L_pfs0
    s_lshl_b32 s37, s3, 12
    buffer_load_dwordx4 v[64:67], v4, s[44:47], s37 offen offset:0 nt
    buffer_load_dwordx4 v[68:71], v4, s[44:47], s37 offen offset:64 nt
    buffer_load_dwordx4 v[72:75], v4, s[44:47], s37 offen offset:128 nt
    buffer_load_dwordx4 v[76:79], v4, s[44:47], s37 offen offset:192 nt
    buffer_load_dwordx4 v[80:83], v5, s[48:51], s37 offen offset:0 nt
    buffer_load_dwordx4 v[84:87], v5, s[48:51], s37 offen offset:256 nt
    buffer_load_dwordx4 v[88:91], v5, s[48:51], s37 offen offset:512 nt
    buffer_load_dwordx4 v[92:95], v5, s[48:51], s37 offen offset:768 nt
    s_add_u32 s37, s37, 32768
L_pfs0:
    s_lshl_b32 s37, s3, 12
    s_add_u32 s37, s37, 32768
    buffer_load_dwordx4 v[96:99], v4, s[44:47], s37 offen offset:0 nt
    buffer_load_dwordx4 v[100:103], v4, s[44:47], s37 offen offset:64 nt
    buffer_load_dwordx4 v[104:107], v4, s[44:47], s37 offen offset:128 nt
    buffer_load_dwordx4 v[108:111], v4, s[44:47], s37 offen offset:192 nt
    buffer_load_dwordx4 v[112:115], v5, s[48:51], s37 offen offset:0 nt
    buffer_load_dwordx4 v[116:119], v5, s[48:51], s37 offen offset:256 nt
    buffer_load_dwordx4 v[120:123], v5, s[48:51], s37 offen offset:512 nt
    buffer_load_dwordx4 v[124:127], v5, s[48:51], s37 offen offset:768 nt
    s_add_u32 s37, s37, 32768
L_pf1:
    s_lshl_b32 s66, s32, 17
    s_add_u32 s56, s12, s66
    s_addc_u32 s57, s13, 0
    s_mov_b32 s58, 0x20000
    s_mov_b32 s59, 0x20000
    s_mov_b32 s39, 0x3e0293ee
    s_mov_b32 s40, 0
    s_getpc_b64 s[74:75]
L_pc:
    s_add_u32 s74, s74, L_rare-L_pc
    s_addc_u32 s75, s75, 0
    v_and_b32 v11, 7, v3
    v_lshrrev_b32 v45, 1, v11
    v_and_b32 v11, 1, v11
    v_lshlrev_b32 v11, 4, v11
    v_mov_b32 v46, 0xffff
    v_lshlrev_b32 v46, v11, v46
    v_cmp_eq_u32 vcc, 0, v45
    s_nop 1
    v_cndmask_b32 v12, 0, v46, vcc
    v_cmp_eq_u32 vcc, 1, v45
    s_nop 1
    v_cndmask_b32 v13, 0, v46, vcc
    v_cmp_eq_u32 vcc, 2, v45
    s_nop 1
    v_cndmask_b32 v14, 0, v46, vcc
    v_cmp_eq_u32 vcc, 3, v45
    s_nop 1
    v_cndmask_b32 v15, 0, v46, vcc
    s_add_u32 s42, s3, s35
    s_and_b32 s42, s42, 3
    s_lshl_b32 s60, s42, 8
    v_lshlrev_b32 v60, 12, v2
    v_lshl_add_u32 v60, v3, 4, v60
    v_add_u32 v60, s60, v60
    v_lshlrev_b32 v9, 5, v3
    v_lshl_add_u32 v9, v2, 4, v9
    s_lshl_b32 s60, s42, 9
    v_add_u32 v61, s60, v9
    s_lshl_b32 s71, s3, 9
    v_add_u32 v9, s71, v9
    s_add_u32 s41, s71, 4096
    v_lshl_add_u32 v62, v2, 4, s41
    s_lshl_b32 s60, s36, 11
    s_add_u32 s76, s30, s60
    s_addc_u32 s77, s31, 0
    v_mov_b32 v63, 1
    v_mov_b32 v7, 0xff61b1e6
    v_mul_f32 v8, s39, v7
    v_mov_b32 v6, 0
    v_mov_b32 v48, 0
    v_mov_b32 v49, 0
    v_mov_b32 v50, 0
    v_mov_b32 v51, 0
    s_waitcnt vmcnt(32)
    s_cmp_lt_u32 s97, 1
    s_cbranch_scc1 L_dx0_1
    s_waitcnt vmcnt(24)
L_dx0_1:
    s_cmp_lt_u32 s3, 4
    s_cbranch_scc1 L_dw0
    s_waitcnt vmcnt(16)
L_dw0:
    s_mov_b32 s60, 0x01000100
    s_mov_b32 s61, 0x03020302
    v_perm_b32 v16, v52, v52, s60
    v_perm_b32 v17, v52, v52, s61
    v_perm_b32 v18, v53, v53, s60
    v_perm_b32 v19, v53, v53, s61
    v_perm_b32 v20, v54, v54, s60
    v_perm_b32 v21, v54, v54, s61
    v_perm_b32 v22, v55, v55, s60
    v_perm_b32 v23, v55, v55, s61
    v_perm_b32 v24, v56, v56, s60
    v_perm_b32 v25, v56, v56, s61
    v_perm_b32 v26, v57, v57, s60
    v_perm_b32 v27, v57, v57, s61
    v_perm_b32 v28, v58, v58, s60
    v_perm_b32 v29, v58, v58, s61
    v_perm_b32 v30, v59, v59, s60
    v_perm_b32 v31, v59, v59, s61
    v_and_b32 v40, v16, v12
    v_and_b32 v41, v16, v13
    v_and_b32 v42, v16, v14
    v_and_b32 v43, v16, v15
    s_waitcnt vmcnt(28)
    s_cmp_lt_u32 s97, 1
    s_cbranch_scc1 L_dx1_1
    s_waitcnt vmcnt(20)
L_dx1_1:
    s_cmp_lt_u32 s3, 4
    s_cbranch_scc1 L_dw1
    s_waitcnt vmcnt(12)
L_dw1:
    v_and_b32 v44, v17, v12
    v_and_b32 v45, v17, v13
    v_and_b32 v46, v17, v14
    v_and_b32 v47, v17, v15
    v_mfma_f32_16x16x32_bf16 v[32:35], v[40:43], v[128:131], 0
    v_and_b32 v40, v18, v12
    v_and_b32 v41, v18, v13
    v_and_b32 v42, v18, v14
    v_and_b32 v43, v18, v15
    v_mfma_f32_16x16x32_bf16 v[32:35], v[44:47], v[132:135], v[32:35]
    v_and_b32 v44, v19, v12
    v_and_b32 v45, v19, v13
    v_and_b32 v46, v19, v14
    v_and_b32 v47, v19, v15
    v_mfma_f32_16x16x32_bf16 v[32:35], v[40:43], v[136:139], v[32:35]
    v_and_b32 v40, v20, v12
    v_and_b32 v41, v20, v13
    v_and_b32 v42, v20, v14
    v_and_b32 v43, v20, v15
    v_mfma_f32_16x16x32_bf16 v[32:35], v[44:47], v[140:143], v[32:35]
    s_waitcnt vmcnt(24)
    s_cmp_lt_u32 s97, 1
    s_cbranch_scc1 L_dx2_1
    s_waitcnt vmcnt(16)
L_dx2_1:
    s_cmp_lt_u32 s3, 4
    s_cbranch_scc1 L_dw2
    s_waitcnt vmcnt(8)
L_dw2:
    v_and_b32 v44, v21, v12
    v_and_b32 v45, v21, v13
    v_and_b32 v46, v21, v14
    v_and_b32 v47, v21, v15
    v_mfma_f32_16x16x32_bf16 v[32:35], v[40:43], v[144:147], v[32:35]
    v_and_b32 v40, v22, v12
    v_and_b32 v41, v22, v13
    v_and_b32 v42, v22, v14
    v_and_b32 v43, v22, v15
    v_mfma_f32_16x16x32_bf16 v[32:35], v[44:47], v[148:151], v[32:35]
    v_and_b32 v44, v23, v12
    v_and_b32 v45, v23, v13
    v_and_b32 v46, v23, v14
    v_and_b32 v47, v23, v15
    v_mfma_f32_16x16x32_bf16 v[32:35], v[40:43], v[152:155], v[32:35]
    v_and_b32 v40, v24, v12
    v_and_b32 v41, v24, v13
    v_and_b32 v42, v24, v14
    v_and_b32 v43, v24, v15
    v_mfma_f32_16x16x32_bf16 v[32:35], v[44:47], v[156:159], v[32:35]
    s_waitcnt vmcnt(20)
    s_cmp_lt_u32 s97, 1
    s_cbranch_scc1 L_dx3_1
    s_waitcnt vmcnt(12)
L_dx3_1:
    s_cmp_lt_u32 s3, 4
    s_cbranch_scc1 L_dw3
    s_waitcnt vmcnt(4)
L_dw3:
    v_and_b32 v44, v25, v12
    v_and_b32 v45, v25, v13
    v_and_b32 v46, v25, v14
    v_and_b32 v47, v25, v15
    v_mfma_f32_16x16x32_bf16 v[32:35], v[40:43], v[160:163], v[32:35]
    v_and_b32 v40, v26, v12
    v_and_b32 v41, v26, v13
    v_and_b32 v42, v26, v14
    v_and_b32 v43, v26, v15
    v_mfma_f32_16x16x32_bf16 v[32:35], v[44:47], v[164:167], v[32:35]
    v_and_b32 v44, v27, v12
    v_and_b32 v45, v27, v13
    v_and_b32 v46, v27, v14
    v_and_b32 v47, v27, v15
    v_mfma_f32_16x16x32_bf16 v[32:35], v[40:43], v[168:171], v[32:35]
    v_and_b32 v40, v28, v12
    v_and_b32 v41, v28, v13
    v_and_b32 v42, v28, v14
    v_and_b32 v43, v28, v15
    v_mfma_f32_16x16x32_bf16 v[32:35], v[44:47], v[172:175], v[32:35]
    s_waitcnt vmcnt(16)
    s_cmp_lt_u32 s97, 1
    s_cbranch_scc1 L_dx4_1
    s_waitcnt vmcnt(8)
L_dx4_1:
    s_cmp_lt_u32 s3, 4
    s_cbranch_scc1 L_dw4
    s_waitcnt vmcnt(0)
L_dw4:
    v_and_b32 v44, v29, v12
    v_and_b32 v45, v29, v13
    v_and_b32 v46, v29, v14
    v_and_b32 v47, v29, v15
    v_mfma_f32_16x16x32_bf16 v[32:35], v[40:43], v[176:179], v[32:35]
    v_and_b32 v40, v30, v12
    v_and_b32 v41, v30, v13
    v_and_b32 v42, v30, v14
    v_and_b32 v43, v30, v15
    v_mfma_f32_16x16x32_bf16 v[32:35], v[44:47], v[180:183], v[32:35]
    v_and_b32 v44, v31, v12
    v_and_b32 v45, v31, v13
    v_and_b32 v46, v31, v14
    v_and_b32 v47, v31, v15
    v_mfma_f32_16x16x32_bf16 v[32:35], v[40:43], v[184:187], v[32:35]
    s_nop 0
    v_mfma_f32_16x16x32_bf16 v[32:35], v[44:47], v[188:191], v[32:35]
    s_mov_b32 exec_hi, 0
    s_nop 6
    ds_write_b128 v9, v[32:35] offset:0
    s_mov_b32 exec_hi, -1
    v_mov_b32 v56, 12416
    v_mov_b32 v58, 0
    v_mov_b32 v59, 0
    s_mov_b64 exec, 1
    ds_write_b64 v56, v[58:59]
    s_mov_b64 exec, -1
    s_waitcnt lgkmcnt(0)
    s_barrier
    s_cmp_lt_u32 s3, 4
    s_cbranch_scc1 L_pf2
    s_lshl_b32 s37, s3, 12
    buffer_load_dwordx4 v[64:67], v4, s[44:47], s37 offen offset:0 nt
    buffer_load_dwordx4 v[68:71], v4, s[44:47], s37 offen offset:64 nt
    buffer_load_dwordx4 v[72:75], v4, s[44:47], s37 offen offset:128 nt
    buffer_load_dwordx4 v[76:79], v4, s[44:47], s37 offen offset:192 nt
    buffer_load_dwordx4 v[80:83], v5, s[48:51], s37 offen offset:0 nt
    buffer_load_dwordx4 v[84:87], v5, s[48:51], s37 offen offset:256 nt
    buffer_load_dwordx4 v[88:91], v5, s[48:51], s37 offen offset:512 nt
    buffer_load_dwordx4 v[92:95], v5, s[48:51], s37 offen offset:768 nt
    s_add_u32 s37, s37, 32768
    buffer_load_dwordx4 v[96:99], v4, s[44:47], s37 offen offset:0 nt
    buffer_load_dwordx4 v[100:103], v4, s[44:47], s37 offen offset:64 nt
    buffer_load_dwordx4 v[104:107], v4, s[44:47], s37 offen offset:128 nt
    buffer_load_dwordx4 v[108:111], v4, s[44:47], s37 offen offset:192 nt
    buffer_load_dwordx4 v[112:115], v5, s[48:51], s37 offen offset:0 nt
    buffer_load_dwordx4 v[116:119], v5, s[48:51], s37 offen offset:256 nt
    buffer_load_dwordx4 v[120:123], v5, s[48:51], s37 offen offset:512 nt
    buffer_load_dwordx4 v[124:127], v5, s[48:51], s37 offen offset:768 nt
    s_add_u32 s37, s37, 32768
L_pf2:
    v_lshlrev_b32 v11, 3, v1
    ds_read_b64 v[16:17], v11 offset:0
    ds_read_b64 v[18:19], v11 offset:512
    ds_read_b64 v[20:21], v11 offset:1024
    ds_read_b64 v[22:23], v11 offset:1536
    ds_read_b64 v[24:25], v11 offset:2048
    ds_read_b64 v[26:27], v11 offset:2560
    ds_read_b64 v[28:29], v11 offset:3072
    ds_read_b64 v[30:31], v11 offset:3584
    v_lshlrev_b32 v10, 2, v1
    v_add_u32 v10, s41, v10
    s_waitcnt lgkmcnt(0)
    v_add_f32 v16, v16, v24
    v_add_f32 v17, v17, v25
    v_add_f32 v18, v18, v26
    v_add_f32 v19, v19, v27
    v_add_f32 v20, v20, v28
    v_add_f32 v21, v21, v29
    v_add_f32 v22, v22, v30
    v_add_f32 v23, v23, v31
    v_add_f32 v16, v16, v20
    v_add_f32 v17, v17, v21
    v_add_f32 v18, v18, v22
    v_add_f32 v19, v19, v23
    v_add_f32 v16, v16, v18
    v_add_f32 v17, v17, v19
    v_cvt_pk_bf16_f32 v11, v16, v17
    ds_write_b32 v10, v11
    s_waitcnt lgkmcnt(0)
    ds_read_b128 v[16:19], v62 offset:0
    ds_read_b128 v[20:23], v62 offset:64
    ds_read_b128 v[24:27], v62 offset:128
    ds_read_b128 v[28:31], v62 offset:192
    s_lshl_b32 s37, s3, 12
    s_add_u32 s37, s37, 65536
    s_waitcnt lgkmcnt(0)
    s_mul_i32 s96, s32, 3
    s_and_b32 s96, s96, 7
    s_add_u32 s96, s96, 4
    s_cmp_lt_u32 s3, 4
    s_cselect_b32 s96, -1, s96
    s_cmp_eq_u32 s3, 4
    s_cselect_b32 s96, s96, -1
    s_cselect_b32 s98, 2, -1
    v_mov_b32 v59, -1
    s_mov_b32 s38, 15
L_loop:
    s_waitcnt vmcnt(12)
    v_mfma_f32_16x16x32_bf16 v[32:35], v[64:67], v[16:19], 0
    v_mfma_f32_16x16x32_bf16 v[32:35], v[68:71], v[20:23], v[32:35]
    v_mfma_f32_16x16x32_bf16 v[32:35], v[72:75], v[24:27], v[32:35]
    v_mfma_f32_16x16x32_bf16 v[32:35], v[76:79], v[28:31], v[32:35]
    buffer_load_dwordx4 v[64:67], v4, s[44:47], s37 offen offset:0 nt
    buffer_load_dwordx4 v[68:71], v4, s[44:47], s37 offen offset:64 nt
    buffer_load_dwordx4 v[72:75], v4, s[44:47], s37 offen offset:128 nt
    buffer_load_dwordx4 v[76:79], v4, s[44:47], s37 offen offset:192 nt
    s_nop 3
    v_max3_f32 v52, v32, v33, v34
    v_max_f32 v52, v52, v35
    v_cmp_gt_f32 vcc, v52, v7
    s_cbranch_vccnz L_tr0
L_back0:
    v_fma_f32 v32, v32, s39, -v8
    v_fma_f32 v33, v33, s39, -v8
    v_fma_f32 v34, v34, s39, -v8
    v_fma_f32 v35, v35, s39, -v8
    v_exp_f32 v32, v32
    v_exp_f32 v33, v33
    v_exp_f32 v34, v34
    v_exp_f32 v35, v35
    v_add_f32 v52, v32, v33
    v_add_f32 v53, v34, v35
    v_cvt_pk_bf16_f32 v36, v32, v32
    v_cvt_pk_bf16_f32 v37, v33, v33
    v_cvt_pk_bf16_f32 v38, v34, v34
    v_cvt_pk_bf16_f32 v39, v35, v35
    v_add_f32 v52, v52, v53
    v_add_f32 v6, v6, v52
    v_and_b32 v40, v36, v12
    v_and_b32 v41, v36, v13
    v_and_b32 v42, v36, v14
    v_and_b32 v43, v36, v15
    v_and_b32 v44, v37, v12
    v_and_b32 v45, v37, v13
    v_and_b32 v46, v37, v14
    v_and_b32 v47, v37, v15
    s_waitcnt vmcnt(12)
    v_mfma_f32_16x16x32_bf16 v[48:51], v[40:43], v[80:83], v[48:51]
    v_and_b32 v40, v38, v12
    v_and_b32 v41, v38, v13
    v_and_b32 v42, v38, v14
    v_and_b32 v43, v38, v15
    v_mfma_f32_16x16x32_bf16 v[48:51], v[44:47], v[84:87], v[48:51]
    v_and_b32 v44, v39, v12
    v_and_b32 v45, v39, v13
    v_and_b32 v46, v39, v14
    v_and_b32 v47, v39, v15
    v_mfma_f32_16x16x32_bf16 v[48:51], v[40:43], v[88:91], v[48:51]
    s_nop 0
    v_mfma_f32_16x16x32_bf16 v[48:51], v[44:47], v[92:95], v[48:51]
    buffer_load_dwordx4 v[80:83], v5, s[48:51], s37 offen offset:0 nt
    buffer_load_dwordx4 v[84:87], v5, s[48:51], s37 offen offset:256 nt
    buffer_load_dwordx4 v[88:91], v5, s[48:51], s37 offen offset:512 nt
    buffer_load_dwordx4 v[92:95], v5, s[48:51], s37 offen offset:768 nt
    s_add_u32 s37, s37, 32768
    s_waitcnt vmcnt(12)
    v_mfma_f32_16x16x32_bf16 v[32:35], v[96:99], v[16:19], 0
    v_mfma_f32_16x16x32_bf16 v[32:35], v[100:103], v[20:23], v[32:35]
    v_mfma_f32_16x16x32_bf16 v[32:35], v[104:107], v[24:27], v[32:35]
    v_mfma_f32_16x16x32_bf16 v[32:35], v[108:111], v[28:31], v[32:35]
    buffer_load_dwordx4 v[96:99], v4, s[44:47], s37 offen offset:0 nt
    buffer_load_dwordx4 v[100:103], v4, s[44:47], s37 offen offset:64 nt
    buffer_load_dwordx4 v[104:107], v4, s[44:47], s37 offen offset:128 nt
    buffer_load_dwordx4 v[108:111], v4, s[44:47], s37 offen offset:192 nt
    s_nop 3
    v_max3_f32 v52, v32, v33, v34
    v_max_f32 v52, v52, v35
    v_cmp_gt_f32 vcc, v52, v7
    s_cbranch_vccnz L_tr1
L_back1:
    v_fma_f32 v32, v32, s39, -v8
    v_fma_f32 v33, v33, s39, -v8
    v_fma_f32 v34, v34, s39, -v8
    v_fma_f32 v35, v35, s39, -v8
    v_exp_f32 v32, v32
    v_exp_f32 v33, v33
    v_exp_f32 v34, v34
    v_exp_f32 v35, v35
    v_add_f32 v52, v32, v33
    v_add_f32 v53, v34, v35
    v_cvt_pk_bf16_f32 v36, v32, v32
    v_cvt_pk_bf16_f32 v37, v33, v33
    v_cvt_pk_bf16_f32 v38, v34, v34
    v_cvt_pk_bf16_f32 v39, v35, v35
    v_add_f32 v52, v52, v53
    v_add_f32 v6, v6, v52
    v_and_b32 v40, v36, v12
    v_and_b32 v41, v36, v13
    v_and_b32 v42, v36, v14
    v_and_b32 v43, v36, v15
    v_and_b32 v44, v37, v12
    v_and_b32 v45, v37, v13
    v_and_b32 v46, v37, v14
    v_and_b32 v47, v37, v15
    s_waitcnt vmcnt(12)
    v_mfma_f32_16x16x32_bf16 v[48:51], v[40:43], v[112:115], v[48:51]
    v_and_b32 v40, v38, v12
    v_and_b32 v41, v38, v13
    v_and_b32 v42, v38, v14
    v_and_b32 v43, v38, v15
    v_mfma_f32_16x16x32_bf16 v[48:51], v[44:47], v[116:119], v[48:51]
    v_and_b32 v44, v39, v12
    v_and_b32 v45, v39, v13
    v_and_b32 v46, v39, v14
    v_and_b32 v47, v39, v15
    v_mfma_f32_16x16x32_bf16 v[48:51], v[40:43], v[120:123], v[48:51]
    s_nop 0
    v_mfma_f32_16x16x32_bf16 v[48:51], v[44:47], v[124:127], v[48:51]
    buffer_load_dwordx4 v[112:115], v5, s[48:51], s37 offen offset:0 nt
    buffer_load_dwordx4 v[116:119], v5, s[48:51], s37 offen offset:256 nt
    buffer_load_dwordx4 v[120:123], v5, s[48:51], s37 offen offset:512 nt
    buffer_load_dwordx4 v[124:127], v5, s[48:51], s37 offen offset:768 nt
    s_add_u32 s37, s37, 32768
    s_cmp_lg_u32 s38, s96
    s_cbranch_scc1 L_norel
    v_mov_b32 v54, 12416
    s_mov_b64 exec, 1
    ds_write_b32 v54, v63 offset:4
    s_mov_b64 exec, -1
L_norel:
    s_cmp_lg_u32 s38, s98
    s_cbranch_scc1 L_noclaim
    s_lshr_b32 s60, s2, 3
    s_and_b32 s60, s60, 7
    s_lshl_b32 s61, s60, 5
    v_mov_b32 v54, s61
    s_mov_b64 exec, 1
    global_atomic_add v59, v54, v63, s[28:29] sc0
    s_mov_b64 exec, -1
L_noclaim:
    s_sub_u32 s38, s38, 1
    s_cmp_lg_u32 s38, 0
    s_cbranch_scc1 L_loop
    s_mov_b32 s98, 0
    s_cmp_lt_u32 s3, 4
    s_cbranch_scc1 L_notask
    v_mov_b32 v53, 12416
    s_cmp_lg_u32 s3, 4
    s_cbranch_scc1 L_spin
    s_waitcnt vmcnt(16)
    v_readfirstlane_b32 s43, v59
    s_cmp_lg_u32 s43, -1
    s_cbranch_scc1 L_have
    s_waitcnt vmcnt(0)
    v_readfirstlane_b32 s43, v59
L_have:
    s_lshr_b32 s60, s2, 3
    s_and_b32 s60, s60, 7
    s_mul_i32 s60, s60, 7
    s_add_u32 s60, s60, s43
    s_cmp_lt_u32 s43, 7
    s_cselect_b32 s43, s60, 56
    s_add_u32 s60, s43, 1
    v_mov_b32 v54, s60
    s_mov_b64 exec, 1
    ds_write_b32 v53, v54
    s_mov_b64 exec, -1
    s_branch L_known
L_spin:
    ds_read_b32 v54, v53
    s_waitcnt lgkmcnt(0)
    v_readfirstlane_b32 s43, v54
    s_cmp_eq_u32 s43, 0
    s_cbranch_scc1 L_spin
    s_sub_u32 s43, s43, 1
L_known:
    s_cmp_ge_u32 s43, 56
    s_cbranch_scc1 L_notask
    s_mov_b32 s98, 1
    s_sub_u32 s69, s3, 4
    s_lshl_b32 s60, s43, 6
    s_add_u32 s44, s16, s60
    s_addc_u32 s45, s17, 0
    s_sub_u32 s46, 0x1c0000, s60
    s_mov_b32 s47, 0x20000
    s_lshl_b32 s61, s43, 15
    s_add_u32 s48, s20, s61
    s_addc_u32 s49, s21, 0
    s_mov_b32 s50, 0x8000
    s_mov_b32 s51, 0x20000
    s_add_u32 s18, s18, s60
    s_addc_u32 s19, s19, 0
    s_lshl_b32 s62, s69, 7
    v_lshrrev_b32 v53, 2, v3
    v_lshlrev_b32 v53, 5, v53
    v_lshl_add_u32 v53, v2, 2, v53
    v_add_u32 v53, s62, v53
    s_movk_i32 s63, 3584
    v_mul_lo_u32 v53, v53, s63
    v_and_b32 v54, 3, v3
    v_lshl_add_u32 v53, v54, 4, v53
    v_mov_b32 v55, v53
    v_lshlrev_b32 v56, 12, v2
    v_lshl_add_u32 v56, v3, 4, v56
    s_lshl_b32 s62, s69, 8
    v_add_u32 v56, s62, v56
    v_and_b32 v58, 31, v1
    v_lshlrev_b32 v58, 1, v58
L_notask:
    s_waitcnt vmcnt(12)
    v_mfma_f32_16x16x32_bf16 v[32:35], v[64:67], v[16:19], 0
    v_mfma_f32_16x16x32_bf16 v[32:35], v[68:71], v[20:23], v[32:35]
    v_mfma_f32_16x16x32_bf16 v[32:35], v[72:75], v[24:27], v[32:35]
    v_mfma_f32_16x16x32_bf16 v[32:35], v[76:79], v[28:31], v[32:35]
    s_cmp_eq_u32 s98, 0
    s_cbranch_scc1 L_sl0
    s_mov_b32 s37, 0
    buffer_load_dwordx4 v[128:131], v55, s[44:47], s37 offen
    s_mov_b32 s37, 3584
    buffer_load_dwordx4 v[132:135], v55, s[44:47], s37 offen
    s_mov_b32 s37, 7168
    buffer_load_dwordx4 v[136:139], v55, s[44:47], s37 offen
    s_mov_b32 s37, 10752
    buffer_load_dwordx4 v[140:143], v55, s[44:47], s37 offen
L_sl0:
    s_nop 7
    v_max3_f32 v52, v32, v33, v34
    v_max_f32 v52, v52, v35
    v_cmp_gt_f32 vcc, v52, v7
    s_cbranch_vccnz L_tr2
L_back2:
    v_fma_f32 v32, v32, s39, -v8
    v_fma_f32 v33, v33, s39, -v8
    v_fma_f32 v34, v34, s39, -v8
    v_fma_f32 v35, v35, s39, -v8
    v_exp_f32 v32, v32
    v_exp_f32 v33, v33
    v_exp_f32 v34, v34
    v_exp_f32 v35, v35
    v_add_f32 v52, v32, v33
    v_add_f32 v53, v34, v35
    v_cvt_pk_bf16_f32 v36, v32, v32
    v_cvt_pk_bf16_f32 v37, v33, v33
    v_cvt_pk_bf16_f32 v38, v34, v34
    v_cvt_pk_bf16_f32 v39, v35, v35
    v_add_f32 v52, v52, v53
    v_add_f32 v6, v6, v52
    v_and_b32 v40, v36, v12
    v_and_b32 v41, v36, v13
    v_and_b32 v42, v36, v14
    v_and_b32 v43, v36, v15
    v_and_b32 v44, v37, v12
    v_and_b32 v45, v37, v13
    v_and_b32 v46, v37, v14
    v_and_b32 v47, v37, v15
    s_waitcnt vmcnt(12)
    s_cmp_lg_u32 s98, 0
    s_cbranch_scc1 L_tw1
    s_waitcnt vmcnt(8)
L_tw1:
    v_mfma_f32_16x16x32_bf16 v[48:51], v[40:43], v[80:83], v[48:51]
    v_and_b32 v40, v38, v12
    v_and_b32 v41, v38, v13
    v_and_b32 v42, v38, v14
    v_and_b32 v43, v38, v15
    v_mfma_f32_16x16x32_bf16 v[48:51], v[44:47], v[84:87], v[48:51]
    v_and_b32 v44, v39, v12
    v_and_b32 v45, v39, v13
    v_and_b32 v46, v39, v14
    v_and_b32 v47, v39, v15
    v_mfma_f32_16x16x32_bf16 v[48:51], v[40:43], v[88:91], v[48:51]
    s_nop 0
    v_mfma_f32_16x16x32_bf16 v[48:51], v[44:47], v[92:95], v[48:51]
    s_cmp_eq_u32 s98, 0
    s_cbranch_scc1 L_sl2
    s_mov_b32 s37, 57344
    buffer_load_dwordx4 v[144:147], v55, s[44:47], s37 offen
    s_mov_b32 s37, 60928
    buffer_load_dwordx4 v[148:151], v55, s[44:47], s37 offen
    s_mov_b32 s37, 64512
    buffer_load_dwordx4 v[152:155], v55, s[44:47], s37 offen
    s_mov_b32 s37, 68096
    buffer_load_dwordx4 v[156:159], v55, s[44:47], s37 offen
L_sl2:
    s_waitcnt vmcnt(12)
    s_cmp_lg_u32 s98, 0
    s_cbranch_scc1 L_tw3
    s_waitcnt vmcnt(4)
L_tw3:
    v_mfma_f32_16x16x32_bf16 v[32:35], v[96:99], v[16:19], 0
    v_mfma_f32_16x16x32_bf16 v[32:35], v[100:103], v[20:23], v[32:35]
    v_mfma_f32_16x16x32_bf16 v[32:35], v[104:107], v[24:27], v[32:35]
    v_mfma_f32_16x16x32_bf16 v[32:35], v[108:111], v[28:31], v[32:35]
    s_cmp_eq_u32 s98, 0
    s_cbranch_scc1 L_sl4
    s_mov_b32 s37, 0
    buffer_load_dwordx4 v[160:163], v56, s[48:51], s37 offen offset:0
    buffer_load_dwordx4 v[164:167], v56, s[48:51], s37 offen offset:1024
    buffer_load_dwordx4 v[168:171], v56, s[48:51], s37 offen offset:2048
    buffer_load_dwordx4 v[172:175], v56, s[48:51], s37 offen offset:3072
L_sl4:
    s_nop 7
    v_max3_f32 v52, v32, v33, v34
    v_max_f32 v52, v52, v35
    v_cmp_gt_f32 vcc, v52, v7
    s_cbranch_vccnz L_tr3
L_back3:
    v_fma_f32 v32, v32, s39, -v8
    v_fma_f32 v33, v33, s39, -v8
    v_fma_f32 v34, v34, s39, -v8
    v_fma_f32 v35, v35, s39, -v8
    v_exp_f32 v32, v32
    v_exp_f32 v33, v33
    v_exp_f32 v34, v34
    v_exp_f32 v35, v35
    v_add_f32 v52, v32, v33
    v_add_f32 v53, v34, v35
    v_cvt_pk_bf16_f32 v36, v32, v32
    v_cvt_pk_bf16_f32 v37, v33, v33
    v_cvt_pk_bf16_f32 v38, v34, v34
    v_cvt_pk_bf16_f32 v39, v35, v35
    v_add_f32 v52, v52, v53
    v_add_f32 v6, v6, v52
    v_and_b32 v40, v36, v12
    v_and_b32 v41, v36, v13
    v_and_b32 v42, v36, v14
    v_and_b32 v43, v36, v15
    v_and_b32 v44, v37, v12
    v_and_b32 v45, v37, v13
    v_and_b32 v46, v37, v14
    v_and_b32 v47, v37, v15
    s_waitcnt vmcnt(12)
    s_cmp_lg_u32 s98, 0
    s_cbranch_scc1 L_tw5
    s_waitcnt vmcnt(0)
L_tw5:
    v_mfma_f32_16x16x32_bf16 v[48:51], v[40:43], v[112:115], v[48:51]
    v_and_b32 v40, v38, v12
    v_and_b32 v41, v38, v13
    v_and_b32 v42, v38, v14
    v_and_b32 v43, v38, v15
    v_mfma_f32_16x16x32_bf16 v[48:51], v[44:47], v[116:119], v[48:51]
    v_and_b32 v44, v39, v12
    v_and_b32 v45, v39, v13
    v_and_b32 v46, v39, v14
    v_and_b32 v47, v39, v15
    v_mfma_f32_16x16x32_bf16 v[48:51], v[40:43], v[120:123], v[48:51]
    s_nop 0
    v_mfma_f32_16x16x32_bf16 v[48:51], v[44:47], v[124:127], v[48:51]
    s_cmp_eq_u32 s98, 0
    s_cbranch_scc1 L_sl6
    s_mov_b32 s37, 16384
    buffer_load_dwordx4 v[176:179], v56, s[48:51], s37 offen offset:0
    buffer_load_dwordx4 v[180:183], v56, s[48:51], s37 offen offset:1024
    buffer_load_dwordx4 v[184:187], v56, s[48:51], s37 offen offset:2048
    buffer_load_dwordx4 v[188:191], v56, s[48:51], s37 offen offset:3072
L_sl6:
    s_cmp_eq_u32 s98, 0
    s_cbranch_scc1 L_sl7
    global_load_ushort v57, v58, s[18:19]
L_sl7:
    v_readlane_b32 s60, v6, 0
    v_readlane_b32 s61, v6, 16
    v_readlane_b32 s62, v6, 32
    v_readlane_b32 s63, v6, 48
    s_lshl_b32 s64, s3, 3
    v_mov_b32 v53, s60
    v_mov_b32 v54, s64
    v_add_f32 v53, s61, v53
    v_add_f32 v53, s62, v53
    v_add_f32 v53, s63, v53
    v_mov_b32 v52, v7
    s_mov_b32 exec_hi, 0
    ds_write_b128 v9, v[48:51] offset:8192
    s_mov_b32 exec_lo, 1
    ds_write_b64 v54, v[52:53] offset:12288
    s_mov_b64 exec, -1
    s_cmp_lt_u32 s3, 4
    s_cbranch_scc1 L_old
    s_waitcnt lgkmcnt(0)
    s_barrier
    s_cmp_eq_u32 s98, 0
    s_cbranch_scc1 L_fin
    s_sub_u32 s69, s3, 4
    s_lshl_b32 s62, s69, 7
    v_lshrrev_b32 v52, 3, v3
    v_lshlrev_b32 v52, 5, v52
    v_lshl_add_u32 v52, v2, 2, v52
    v_add_u32 v52, s62, v52
    v_lshlrev_b32 v52, 1, v52
    ds_read_b64 v[64:65], v52 offset:21760
    ds_read_b64 v[66:67], v52 offset:21792
    ds_read_b64 v[68:69], v52 offset:21888
    ds_read_b64 v[70:71], v52 offset:21920
    ds_read_b64 v[72:73], v52 offset:22784
    ds_read_b64 v[74:75], v52 offset:22816
    ds_read_b64 v[76:77], v52 offset:22912
    ds_read_b64 v[78:79], v52 offset:22944
    ds_read_b64 v[80:81], v52 offset:23808
    ds_read_b64 v[82:83], v52 offset:23840
    ds_read_b64 v[84:85], v52 offset:23936
    ds_read_b64 v[86:87], v52 offset:23968
    ds_read_b64 v[88:89], v52 offset:24832
    ds_read_b64 v[90:91], v52 offset:24864
    ds_read_b64 v[92:93], v52 offset:24960
    ds_read_b64 v[94:95], v52 offset:24992
    v_lshrrev_b32 v56, 2, v3
    v_lshlrev_b32 v56, 7, v56
    v_and_b32 v58, 3, v3
    v_lshl_add_u32 v56, v58, 5, v56
    v_and_b32 v58, 1, v2
    v_lshl_add_u32 v56, v58, 4, v56
    s_lshl_b32 s62, s69, 11
    v_add_u32 v56, s62, v56
    s_mov_b32 s66, 0x01000100
    s_mov_b32 s67, 0x03020302
    s_waitcnt vmcnt(9) lgkmcnt(0)
    v_perm_b32 v16, v64, v64, s66
    v_perm_b32 v17, v64, v64, s67
    v_perm_b32 v18, v65, v65, s66
    v_perm_b32 v19, v65, v65, s67
    v_perm_b32 v20, v66, v66, s66
    v_perm_b32 v21, v66, v66, s67
    v_perm_b32 v22, v67, v67, s66
    v_perm_b32 v23, v67, v67, s67
    v_perm_b32 v24, v68, v68, s66
    v_perm_b32 v25, v68, v68, s67
    v_perm_b32 v26, v69, v69, s66
    v_perm_b32 v27, v69, v69, s67
    v_perm_b32 v28, v70, v70, s66
    v_perm_b32 v29, v70, v70, s67
    v_perm_b32 v30, v71, v71, s66
    v_perm_b32 v31, v71, v71, s67
    v_and_b32 v40, v16, v12
    v_and_b32 v41, v16, v13
    v_and_b32 v42, v16, v14
    v_and_b32 v43, v16, v15
    v_and_b32 v44, v17, v12
    v_and_b32 v45, v17, v13
    v_and_b32 v46, v17, v14
    v_and_b32 v47, v17, v15
    v_mfma_f32_16x16x32_bf16 v[32:35], v[40:43], v[128:131], 0
    v_and_b32 v40, v18, v12
    v_and_b32 v41, v18, v13
    v_and_b32 v42, v18, v14
    v_and_b32 v43, v18, v15
    v_mfma_f32_16x16x32_bf16 v[32:35], v[44:47], v[132:135], v[32:35]
    v_and_b32 v44, v19, v12
    v_and_b32 v45, v19, v13
    v_and_b32 v46, v19, v14
    v_and_b32 v47, v19, v15
    v_mfma_f32_16x16x32_bf16 v[32:35], v[40:43], v[136:139], v[32:35]
    v_and_b32 v40, v20, v12
    v_and_b32 v41, v20, v13
    v_and_b32 v42, v20, v14
    v_and_b32 v43, v20, v15
    v_mfma_f32_16x16x32_bf16 v[32:35], v[44:47], v[140:143], v[32:35]
    v_and_b32 v44, v21, v12
    v_and_b32 v45, v21, v13
    v_and_b32 v46, v21, v14
    v_and_b32 v47, v21, v15
    v_mfma_f32_16x16x32_bf16 v[32:35], v[40:43], v[144:147], v[32:35]
    v_and_b32 v40, v22, v12
    v_and_b32 v41, v22, v13
    v_and_b32 v42, v22, v14
    v_and_b32 v43, v22, v15
    v_mfma_f32_16x16x32_bf16 v[32:35], v[44:47], v[148:151], v[32:35]
    v_and_b32 v44, v23, v12
    v_and_b32 v45, v23, v13
    v_and_b32 v46, v23, v14
    v_and_b32 v47, v23, v15
    v_mfma_f32_16x16x32_bf16 v[32:35], v[40:43], v[152:155], v[32:35]
    s_nop 0
    v_mfma_f32_16x16x32_bf16 v[32:35], v[44:47], v[156:159], v[32:35]
    v_and_b32 v40, v24, v12
    v_and_b32 v41, v24, v13
    v_and_b32 v42, v24, v14
    v_and_b32 v43, v24, v15
    v_and_b32 v44, v25, v12
    v_and_b32 v45, v25, v13
    v_and_b32 v46, v25, v14
    v_and_b32 v47, v25, v15
    v_mfma_f32_16x16x32_bf16 v[36:39], v[40:43], v[128:131], 0
    v_and_b32 v40, v26, v12
    v_and_b32 v41, v26, v13
    v_and_b32 v42, v26, v14
    v_and_b32 v43, v26, v15
    v_mfma_f32_16x16x32_bf16 v[36:39], v[44:47], v[132:135], v[36:39]
    v_and_b32 v44, v27, v12
    v_and_b32 v45, v27, v13
    v_and_b32 v46, v27, v14
    v_and_b32 v47, v27, v15
    v_mfma_f32_16x16x32_bf16 v[36:39], v[40:43], v[136:139], v[36:39]
    v_and_b32 v40, v28, v12
    v_and_b32 v41, v28, v13
    v_and_b32 v42, v28, v14
    v_and_b32 v43, v28, v15
    v_mfma_f32_16x16x32_bf16 v[36:39], v[44:47], v[140:143], v[36:39]
    v_and_b32 v44, v29, v12
    v_and_b32 v45, v29, v13
    v_and_b32 v46, v29, v14
    v_and_b32 v47, v29, v15
    v_mfma_f32_16x16x32_bf16 v[36:39], v[40:43], v[144:147], v[36:39]
    v_and_b32 v40, v30, v12
    v_and_b32 v41, v30, v13
    v_and_b32 v42, v30, v14
    v_and_b32 v43, v30, v15
    v_mfma_f32_16x16x32_bf16 v[36:39], v[44:47], v[148:151], v[36:39]
    v_and_b32 v44, v31, v12
    v_and_b32 v45, v31, v13
    v_and_b32 v46, v31, v14
    v_and_b32 v47, v31, v15
    v_mfma_f32_16x16x32_bf16 v[36:39], v[40:43], v[152:155], v[36:39]
    s_nop 0
    v_mfma_f32_16x16x32_bf16 v[36:39], v[44:47], v[156:159], v[36:39]
    s_mov_b32 exec_lo, 0x000f000f
    s_mov_b32 exec_hi, 0x00f000f0
    ds_write_b128 v56, v[32:35] offset:13568
    s_mov_b32 exec_lo, 0x0f000f00
    s_mov_b32 exec_hi, 0xf000f000
    s_nop 2
    ds_write_b128 v56, v[36:39] offset:13568
    s_mov_b64 exec, -1
    v_perm_b32 v16, v72, v72, s66
    v_perm_b32 v17, v72, v72, s67
    v_perm_b32 v18, v73, v73, s66
    v_perm_b32 v19, v73, v73, s67
    v_perm_b32 v20, v74, v74, s66
    v_perm_b32 v21, v74, v74, s67
    v_perm_b32 v22, v75, v75, s66
    v_perm_b32 v23, v75, v75, s67
    v_perm_b32 v24, v76, v76, s66
    v_perm_b32 v25, v76, v76, s67
    v_perm_b32 v26, v77, v77, s66
    v_perm_b32 v27, v77, v77, s67
    v_perm_b32 v28, v78, v78, s66
    v_perm_b32 v29, v78, v78, s67
    v_perm_b32 v30, v79, v79, s66
    v_perm_b32 v31, v79, v79, s67
    v_and_b32 v40, v16, v12
    v_and_b32 v41, v16, v13
    v_and_b32 v42, v16, v14
    v_and_b32 v43, v16, v15
    v_and_b32 v44, v17, v12
    v_and_b32 v45, v17, v13
    v_and_b32 v46, v17, v14
    v_and_b32 v47, v17, v15
    v_mfma_f32_16x16x32_bf16 v[32:35], v[40:43], v[128:131], 0
    v_and_b32 v40, v18, v12
    v_and_b32 v41, v18, v13
    v_and_b32 v42, v18, v14
    v_and_b32 v43, v18, v15
    v_mfma_f32_16x16x32_bf16 v[32:35], v[44:47], v[132:135], v[32:35]
    v_and_b32 v44, v19, v12
    v_and_b32 v45, v19, v13
    v_and_b32 v46, v19, v14
    v_and_b32 v47, v19, v15
    v_mfma_f32_16x16x32_bf16 v[32:35], v[40:43], v[136:139], v[32:35]
    v_and_b32 v40, v20, v12
    v_and_b32 v41, v20, v13
    v_and_b32 v42, v20, v14
    v_and_b32 v43, v20, v15
    v_mfma_f32_16x16x32_bf16 v[32:35], v[44:47], v[140:143], v[32:35]
    v_and_b32 v44, v21, v12
    v_and_b32 v45, v21, v13
    v_and_b32 v46, v21, v14
    v_and_b32 v47, v21, v15
    v_mfma_f32_16x16x32_bf16 v[32:35], v[40:43], v[144:147], v[32:35]
    v_and_b32 v40, v22, v12
    v_and_b32 v41, v22, v13
    v_and_b32 v42, v22, v14
    v_and_b32 v43, v22, v15
    v_mfma_f32_16x16x32_bf16 v[32:35], v[44:47], v[148:151], v[32:35]
    v_and_b32 v44, v23, v12
    v_and_b32 v45, v23, v13
    v_and_b32 v46, v23, v14
    v_and_b32 v47, v23, v15
    v_mfma_f32_16x16x32_bf16 v[32:35], v[40:43], v[152:155], v[32:35]
    s_nop 0
    v_mfma_f32_16x16x32_bf16 v[32:35], v[44:47], v[156:159], v[32:35]
    v_and_b32 v40, v24, v12
    v_and_b32 v41, v24, v13
    v_and_b32 v42, v24, v14
    v_and_b32 v43, v24, v15
    v_and_b32 v44, v25, v12
    v_and_b32 v45, v25, v13
    v_and_b32 v46, v25, v14
    v_and_b32 v47, v25, v15
    v_mfma_f32_16x16x32_bf16 v[36:39], v[40:43], v[128:131], 0
    v_and_b32 v40, v26, v12
    v_and_b32 v41, v26, v13
    v_and_b32 v42, v26, v14
    v_and_b32 v43, v26, v15
    v_mfma_f32_16x16x32_bf16 v[36:39], v[44:47], v[132:135], v[36:39]
    v_and_b32 v44, v27, v12
    v_and_b32 v45, v27, v13
    v_and_b32 v46, v27, v14
    v_and_b32 v47, v27, v15
    v_mfma_f32_16x16x32_bf16 v[36:39], v[40:43], v[136:139], v[36:39]
    v_and_b32 v40, v28, v12
    v_and_b32 v41, v28, v13
    v_and_b32 v42, v28, v14
    v_and_b32 v43, v28, v15
    v_mfma_f32_16x16x32_bf16 v[36:39], v[44:47], v[140:143], v[36:39]
    v_and_b32 v44, v29, v12
    v_and_b32 v45, v29, v13
    v_and_b32 v46, v29, v14
    v_and_b32 v47, v29, v15
    v_mfma_f32_16x16x32_bf16 v[36:39], v[40:43], v[144:147], v[36:39]
    v_and_b32 v40, v30, v12
    v_and_b32 v41, v30, v13
    v_and_b32 v42, v30, v14
    v_and_b32 v43, v30, v15
    v_mfma_f32_16x16x32_bf16 v[36:39], v[44:47], v[148:151], v[36:39]
    v_and_b32 v44, v31, v12
    v_and_b32 v45, v31, v13
    v_and_b32 v46, v31, v14
    v_and_b32 v47, v31, v15
    v_mfma_f32_16x16x32_bf16 v[36:39], v[40:43], v[152:155], v[36:39]
    s_nop 0
    v_mfma_f32_16x16x32_bf16 v[36:39], v[44:47], v[156:159], v[36:39]
    s_mov_b32 exec_lo, 0x000f000f
    s_mov_b32 exec_hi, 0x00f000f0
    ds_write_b128 v56, v[32:35] offset:14080
    s_mov_b32 exec_lo, 0x0f000f00
    s_mov_b32 exec_hi, 0xf000f000
    s_nop 2
    ds_write_b128 v56, v[36:39] offset:14080
    s_mov_b64 exec, -1
    v_perm_b32 v16, v80, v80, s66
    v_perm_b32 v17, v80, v80, s67
    v_perm_b32 v18, v81, v81, s66
    v_perm_b32 v19, v81, v81, s67
    v_perm_b32 v20, v82, v82, s66
    v_perm_b32 v21, v82, v82, s67
    v_perm_b32 v22, v83, v83, s66
    v_perm_b32 v23, v83, v83, s67
    v_perm_b32 v24, v84, v84, s66
    v_perm_b32 v25, v84, v84, s67
    v_perm_b32 v26, v85, v85, s66
    v_perm_b32 v27, v85, v85, s67
    v_perm_b32 v28, v86, v86, s66
    v_perm_b32 v29, v86, v86, s67
    v_perm_b32 v30, v87, v87, s66
    v_perm_b32 v31, v87, v87, s67
    v_and_b32 v40, v16, v12
    v_and_b32 v41, v16, v13
    v_and_b32 v42, v16, v14
    v_and_b32 v43, v16, v15
    v_and_b32 v44, v17, v12
    v_and_b32 v45, v17, v13
    v_and_b32 v46, v17, v14
    v_and_b32 v47, v17, v15
    v_mfma_f32_16x16x32_bf16 v[32:35], v[40:43], v[128:131], 0
    v_and_b32 v40, v18, v12
    v_and_b32 v41, v18, v13
    v_and_b32 v42, v18, v14
    v_and_b32 v43, v18, v15
    v_mfma_f32_16x16x32_bf16 v[32:35], v[44:47], v[132:135], v[32:35]
    v_and_b32 v44, v19, v12
    v_and_b32 v45, v19, v13
    v_and_b32 v46, v19, v14
    v_and_b32 v47, v19, v15
    v_mfma_f32_16x16x32_bf16 v[32:35], v[40:43], v[136:139], v[32:35]
    v_and_b32 v40, v20, v12
    v_and_b32 v41, v20, v13
    v_and_b32 v42, v20, v14
    v_and_b32 v43, v20, v15
    v_mfma_f32_16x16x32_bf16 v[32:35], v[44:47], v[140:143], v[32:35]
    v_and_b32 v44, v21, v12
    v_and_b32 v45, v21, v13
    v_and_b32 v46, v21, v14
    v_and_b32 v47, v21, v15
    v_mfma_f32_16x16x32_bf16 v[32:35], v[40:43], v[144:147], v[32:35]
    v_and_b32 v40, v22, v12
    v_and_b32 v41, v22, v13
    v_and_b32 v42, v22, v14
    v_and_b32 v43, v22, v15
    v_mfma_f32_16x16x32_bf16 v[32:35], v[44:47], v[148:151], v[32:35]
    v_and_b32 v44, v23, v12
    v_and_b32 v45, v23, v13
    v_and_b32 v46, v23, v14
    v_and_b32 v47, v23, v15
    v_mfma_f32_16x16x32_bf16 v[32:35], v[40:43], v[152:155], v[32:35]
    s_nop 0
    v_mfma_f32_16x16x32_bf16 v[32:35], v[44:47], v[156:159], v[32:35]
    v_and_b32 v40, v24, v12
    v_and_b32 v41, v24, v13
    v_and_b32 v42, v24, v14
    v_and_b32 v43, v24, v15
    v_and_b32 v44, v25, v12
    v_and_b32 v45, v25, v13
    v_and_b32 v46, v25, v14
    v_and_b32 v47, v25, v15
    v_mfma_f32_16x16x32_bf16 v[36:39], v[40:43], v[128:131], 0
    v_and_b32 v40, v26, v12
    v_and_b32 v41, v26, v13
    v_and_b32 v42, v26, v14
    v_and_b32 v43, v26, v15
    v_mfma_f32_16x16x32_bf16 v[36:39], v[44:47], v[132:135], v[36:39]
    v_and_b32 v44, v27, v12
    v_and_b32 v45, v27, v13
    v_and_b32 v46, v27, v14
    v_and_b32 v47, v27, v15
    v_mfma_f32_16x16x32_bf16 v[36:39], v[40:43], v[136:139], v[36:39]
    v_and_b32 v40, v28, v12
    v_and_b32 v41, v28, v13
    v_and_b32 v42, v28, v14
    v_and_b32 v43, v28, v15
    v_mfma_f32_16x16x32_bf16 v[36:39], v[44:47], v[140:143], v[36:39]
    v_and_b32 v44, v29, v12
    v_and_b32 v45, v29, v13
    v_and_b32 v46, v29, v14
    v_and_b32 v47, v29, v15
    v_mfma_f32_16x16x32_bf16 v[36:39], v[40:43], v[144:147], v[36:39]
    v_and_b32 v40, v30, v12
    v_and_b32 v41, v30, v13
    v_and_b32 v42, v30, v14
    v_and_b32 v43, v30, v15
    v_mfma_f32_16x16x32_bf16 v[36:39], v[44:47], v[148:151], v[36:39]
    v_and_b32 v44, v31, v12
    v_and_b32 v45, v31, v13
    v_and_b32 v46, v31, v14
    v_and_b32 v47, v31, v15
    v_mfma_f32_16x16x32_bf16 v[36:39], v[40:43], v[152:155], v[36:39]
    s_nop 0
    v_mfma_f32_16x16x32_bf16 v[36:39], v[44:47], v[156:159], v[36:39]
    s_mov_b32 exec_lo, 0x000f000f
    s_mov_b32 exec_hi, 0x00f000f0
    ds_write_b128 v56, v[32:35] offset:14592
    s_mov_b32 exec_lo, 0x0f000f00
    s_mov_b32 exec_hi, 0xf000f000
    s_nop 2
    ds_write_b128 v56, v[36:39] offset:14592
    s_mov_b64 exec, -1
    v_perm_b32 v16, v88, v88, s66
    v_perm_b32 v17, v88, v88, s67
    v_perm_b32 v18, v89, v89, s66
    v_perm_b32 v19, v89, v89, s67
    v_perm_b32 v20, v90, v90, s66
    v_perm_b32 v21, v90, v90, s67
    v_perm_b32 v22, v91, v91, s66
    v_perm_b32 v23, v91, v91, s67
    v_perm_b32 v24, v92, v92, s66
    v_perm_b32 v25, v92, v92, s67
    v_perm_b32 v26, v93, v93, s66
    v_perm_b32 v27, v93, v93, s67
    v_perm_b32 v28, v94, v94, s66
    v_perm_b32 v29, v94, v94, s67
    v_perm_b32 v30, v95, v95, s66
    v_perm_b32 v31, v95, v95, s67
    v_and_b32 v40, v16, v12
    v_and_b32 v41, v16, v13
    v_and_b32 v42, v16, v14
    v_and_b32 v43, v16, v15
    v_and_b32 v44, v17, v12
    v_and_b32 v45, v17, v13
    v_and_b32 v46, v17, v14
    v_and_b32 v47, v17, v15
    v_mfma_f32_16x16x32_bf16 v[32:35], v[40:43], v[128:131], 0
    v_and_b32 v40, v18, v12
    v_and_b32 v41, v18, v13
    v_and_b32 v42, v18, v14
    v_and_b32 v43, v18, v15
    v_mfma_f32_16x16x32_bf16 v[32:35], v[44:47], v[132:135], v[32:35]
    v_and_b32 v44, v19, v12
    v_and_b32 v45, v19, v13
    v_and_b32 v46, v19, v14
    v_and_b32 v47, v19, v15
    v_mfma_f32_16x16x32_bf16 v[32:35], v[40:43], v[136:139], v[32:35]
    v_and_b32 v40, v20, v12
    v_and_b32 v41, v20, v13
    v_and_b32 v42, v20, v14
    v_and_b32 v43, v20, v15
    v_mfma_f32_16x16x32_bf16 v[32:35], v[44:47], v[140:143], v[32:35]
    v_and_b32 v44, v21, v12
    v_and_b32 v45, v21, v13
    v_and_b32 v46, v21, v14
    v_and_b32 v47, v21, v15
    v_mfma_f32_16x16x32_bf16 v[32:35], v[40:43], v[144:147], v[32:35]
    v_and_b32 v40, v22, v12
    v_and_b32 v41, v22, v13
    v_and_b32 v42, v22, v14
    v_and_b32 v43, v22, v15
    v_mfma_f32_16x16x32_bf16 v[32:35], v[44:47], v[148:151], v[32:35]
    v_and_b32 v44, v23, v12
    v_and_b32 v45, v23, v13
    v_and_b32 v46, v23, v14
    v_and_b32 v47, v23, v15
    v_mfma_f32_16x16x32_bf16 v[32:35], v[40:43], v[152:155], v[32:35]
    s_nop 0
    v_mfma_f32_16x16x32_bf16 v[32:35], v[44:47], v[156:159], v[32:35]
    v_and_b32 v40, v24, v12
    v_and_b32 v41, v24, v13
    v_and_b32 v42, v24, v14
    v_and_b32 v43, v24, v15
    v_and_b32 v44, v25, v12
    v_and_b32 v45, v25, v13
    v_and_b32 v46, v25, v14
    v_and_b32 v47, v25, v15
    v_mfma_f32_16x16x32_bf16 v[36:39], v[40:43], v[128:131], 0
    v_and_b32 v40, v26, v12
    v_and_b32 v41, v26, v13
    v_and_b32 v42, v26, v14
    v_and_b32 v43, v26, v15
    v_mfma_f32_16x16x32_bf16 v[36:39], v[44:47], v[132:135], v[36:39]
    v_and_b32 v44, v27, v12
    v_and_b32 v45, v27, v13
    v_and_b32 v46, v27, v14
    v_and_b32 v47, v27, v15
    v_mfma_f32_16x16x32_bf16 v[36:39], v[40:43], v[136:139], v[36:39]
    v_and_b32 v40, v28, v12
    v_and_b32 v41, v28, v13
    v_and_b32 v42, v28, v14
    v_and_b32 v43, v28, v15
    v_mfma_f32_16x16x32_bf16 v[36:39], v[44:47], v[140:143], v[36:39]
    v_and_b32 v44, v29, v12
    v_and_b32 v45, v29, v13
    v_and_b32 v46, v29, v14
    v_and_b32 v47, v29, v15
    v_mfma_f32_16x16x32_bf16 v[36:39], v[40:43], v[144:147], v[36:39]
    v_and_b32 v40, v30, v12
    v_and_b32 v41, v30, v13
    v_and_b32 v42, v30, v14
    v_and_b32 v43, v30, v15
    v_mfma_f32_16x16x32_bf16 v[36:39], v[44:47], v[148:151], v[36:39]
    v_and_b32 v44, v31, v12
    v_and_b32 v45, v31, v13
    v_and_b32 v46, v31, v14
    v_and_b32 v47, v31, v15
    v_mfma_f32_16x16x32_bf16 v[36:39], v[40:43], v[152:155], v[36:39]
    s_nop 0
    v_mfma_f32_16x16x32_bf16 v[36:39], v[44:47], v[156:159], v[36:39]
    s_mov_b32 exec_lo, 0x000f000f
    s_mov_b32 exec_hi, 0x00f000f0
    ds_write_b128 v56, v[32:35] offset:15104
    s_mov_b32 exec_lo, 0x0f000f00
    s_mov_b32 exec_hi, 0xf000f000
    s_nop 2
    ds_write_b128 v56, v[36:39] offset:15104
    s_mov_b64 exec, -1
    s_waitcnt lgkmcnt(0)
    s_barrier
    v_and_b32 v56, 31, v1
    v_lshlrev_b32 v56, 2, v56
    v_lshrrev_b32 v58, 5, v1
    v_lshl_add_u32 v58, v58, 8, v56
    s_lshl_b32 s62, s69, 9
    v_add_u32 v58, s62, v58
    v_add_u32 v58, 13568, v58
    ds_read2_b32 v[16:17], v58 offset0:0 offset1:32
    v_add_u32 v58, 2048, v58
    ds_read2_b32 v[18:19], v58 offset0:0 offset1:32
    v_add_u32 v58, 2048, v58
    ds_read2_b32 v[20:21], v58 offset0:0 offset1:32
    v_add_u32 v58, 2048, v58
    ds_read2_b32 v[22:23], v58 offset0:0 offset1:32
    s_waitcnt vmcnt(0) lgkmcnt(0)
    v_add_f32 v16, v16, v17
    v_add_f32 v18, v18, v19
    v_add_f32 v20, v20, v21
    v_add_f32 v22, v22, v23
    v_add_f32 v16, v16, v18
    v_add_f32 v20, v20, v22
    v_add_f32 v16, v16, v20
    v_mov_b32 v17, v16
    s_nop 1
    v_permlane32_swap_b32 v16, v17
    v_add_f32 v16, v16, v17
    v_cvt_pk_bf16_f32 v16, v16, v16
    v_and_b32 v16, 0xffff0000, v16
    v_lshlrev_b32 v57, 16, v57
    v_add_f32 v16, v16, v57
    v_cvt_pk_bf16_f32 v16, v16, v16
    v_and_b32 v16, 0xffff0000, v16
    v_max_f32 v16, 0, v16
    v_mul_f32 v16, v16, v16
    v_cvt_pk_bf16_f32 v16, v16, v16
    s_lshl_b32 s62, s69, 7
    v_add_u32 v56, s62, v56
    s_mov_b32 exec_hi, 0
    ds_write_b32 v56, v16 offset:12544
    s_mov_b32 exec_hi, -1
    s_waitcnt lgkmcnt(0)
    s_barrier
    v_lshlrev_b32 v56, 4, v2
    ds_read_b128 v[64:67], v56 offset:12544
    ds_read_b128 v[68:71], v56 offset:12608
    ds_read_b128 v[72:75], v56 offset:12672
    ds_read_b128 v[76:79], v56 offset:12736
    ds_read_b128 v[80:83], v56 offset:12800
    ds_read_b128 v[84:87], v56 offset:12864
    ds_read_b128 v[88:91], v56 offset:12928
    ds_read_b128 v[92:95], v56 offset:12992
    v_lshlrev_b32 v58, 5, v3
    v_lshl_add_u32 v58, v2, 4, v58
    s_lshl_b32 s62, s69, 9
    v_add_u32 v58, s62, v58
    s_lshl_b32 s62, s43, 11
    s_add_u32 s62, s62, 0x80000
    s_add_u32 s76, s30, s62
    s_addc_u32 s77, s31, 0
    s_waitcnt lgkmcnt(0)
    v_and_b32 v40, v64, v12
    v_and_b32 v41, v64, v13
    v_and_b32 v42, v64, v14
    v_and_b32 v43, v64, v15
    v_and_b32 v44, v65, v12
    v_and_b32 v45, v65, v13
    v_and_b32 v46, v65, v14
    v_and_b32 v47, v65, v15
    v_mfma_f32_16x16x32_bf16 v[32:35], v[40:43], v[160:163], 0
    v_and_b32 v40, v66, v12
    v_and_b32 v41, v66, v13
    v_and_b32 v42, v66, v14
    v_and_b32 v43, v66, v15
    v_mfma_f32_16x16x32_bf16 v[32:35], v[44:47], v[164:167], v[32:35]
    v_and_b32 v44, v67, v12
    v_and_b32 v45, v67, v13
    v_and_b32 v46, v67, v14
    v_and_b32 v47, v67, v15
    v_mfma_f32_16x16x32_bf16 v[32:35], v[40:43], v[168:171], v[32:35]
    v_and_b32 v40, v68, v12
    v_and_b32 v41, v68, v13
    v_and_b32 v42, v68, v14
    v_and_b32 v43, v68, v15
    v_mfma_f32_16x16x32_bf16 v[32:35], v[44:47], v[172:175], v[32:35]
    v_and_b32 v44, v69, v12
    v_and_b32 v45, v69, v13
    v_and_b32 v46, v69, v14
    v_and_b32 v47, v69, v15
    v_mfma_f32_16x16x32_bf16 v[32:35], v[40:43], v[176:179], v[32:35]
    v_and_b32 v40, v70, v12
    v_and_b32 v41, v70, v13
    v_and_b32 v42, v70, v14
    v_and_b32 v43, v70, v15
    v_mfma_f32_16x16x32_bf16 v[32:35], v[44:47], v[180:183], v[32:35]
    v_and_b32 v44, v71, v12
    v_and_b32 v45, v71, v13
    v_and_b32 v46, v71, v14
    v_and_b32 v47, v71, v15
    v_mfma_f32_16x16x32_bf16 v[32:35], v[40:43], v[184:187], v[32:35]
    s_nop 0
    v_mfma_f32_16x16x32_bf16 v[32:35], v[44:47], v[188:191], v[32:35]
    s_mov_b32 exec_hi, 0
    s_nop 6
    global_store_dwordx4 v58, v[32:35], s[76:77]
    s_mov_b32 exec_hi, -1
    s_add_u32 s76, s76, 114688
    s_addc_u32 s77, s77, 0
    v_and_b32 v40, v72, v12
    v_and_b32 v41, v72, v13
    v_and_b32 v42, v72, v14
    v_and_b32 v43, v72, v15
    v_and_b32 v44, v73, v12
    v_and_b32 v45, v73, v13
    v_and_b32 v46, v73, v14
    v_and_b32 v47, v73, v15
    v_mfma_f32_16x16x32_bf16 v[36:39], v[40:43], v[160:163], 0
    v_and_b32 v40, v74, v12
    v_and_b32 v41, v74, v13
    v_and_b32 v42, v74, v14
    v_and_b32 v43, v74, v15
    v_mfma_f32_16x16x32_bf16 v[36:39], v[44:47], v[164:167], v[36:39]
    v_and_b32 v44, v75, v12
    v_and_b32 v45, v75, v13
    v_and_b32 v46, v75, v14
    v_and_b32 v47, v75, v15
    v_mfma_f32_16x16x32_bf16 v[36:39], v[40:43], v[168:171], v[36:39]
    v_and_b32 v40, v76, v12
    v_and_b32 v41, v76, v13
    v_and_b32 v42, v76, v14
    v_and_b32 v43, v76, v15
    v_mfma_f32_16x16x32_bf16 v[36:39], v[44:47], v[172:175], v[36:39]
    v_and_b32 v44, v77, v12
    v_and_b32 v45, v77, v13
    v_and_b32 v46, v77, v14
    v_and_b32 v47, v77, v15
    v_mfma_f32_16x16x32_bf16 v[36:39], v[40:43], v[176:179], v[36:39]
    v_and_b32 v40, v78, v12
    v_and_b32 v41, v78, v13
    v_and_b32 v42, v78, v14
    v_and_b32 v43, v78, v15
    v_mfma_f32_16x16x32_bf16 v[36:39], v[44:47], v[180:183], v[36:39]
    v_and_b32 v44, v79, v12
    v_and_b32 v45, v79, v13
    v_and_b32 v46, v79, v14
    v_and_b32 v47, v79, v15
    v_mfma_f32_16x16x32_bf16 v[36:39], v[40:43], v[184:187], v[36:39]
    s_nop 0
    v_mfma_f32_16x16x32_bf16 v[36:39], v[44:47], v[188:191], v[36:39]
    s_mov_b32 exec_hi, 0
    s_nop 6
    global_store_dwordx4 v58, v[36:39], s[76:77]
    s_mov_b32 exec_hi, -1
    s_add_u32 s76, s76, 114688
    s_addc_u32 s77, s77, 0
    v_and_b32 v40, v80, v12
    v_and_b32 v41, v80, v13
    v_and_b32 v42, v80, v14
    v_and_b32 v43, v80, v15
    v_and_b32 v44, v81, v12
    v_and_b32 v45, v81, v13
    v_and_b32 v46, v81, v14
    v_and_b32 v47, v81, v15
    v_mfma_f32_16x16x32_bf16 v[32:35], v[40:43], v[160:163], 0
    v_and_b32 v40, v82, v12
    v_and_b32 v41, v82, v13
    v_and_b32 v42, v82, v14
    v_and_b32 v43, v82, v15
    v_mfma_f32_16x16x32_bf16 v[32:35], v[44:47], v[164:167], v[32:35]
    v_and_b32 v44, v83, v12
    v_and_b32 v45, v83, v13
    v_and_b32 v46, v83, v14
    v_and_b32 v47, v83, v15
    v_mfma_f32_16x16x32_bf16 v[32:35], v[40:43], v[168:171], v[32:35]
    v_and_b32 v40, v84, v12
    v_and_b32 v41, v84, v13
    v_and_b32 v42, v84, v14
    v_and_b32 v43, v84, v15
    v_mfma_f32_16x16x32_bf16 v[32:35], v[44:47], v[172:175], v[32:35]
    v_and_b32 v44, v85, v12
    v_and_b32 v45, v85, v13
    v_and_b32 v46, v85, v14
    v_and_b32 v47, v85, v15
    v_mfma_f32_16x16x32_bf16 v[32:35], v[40:43], v[176:179], v[32:35]
    v_and_b32 v40, v86, v12
    v_and_b32 v41, v86, v13
    v_and_b32 v42, v86, v14
    v_and_b32 v43, v86, v15
    v_mfma_f32_16x16x32_bf16 v[32:35], v[44:47], v[180:183], v[32:35]
    v_and_b32 v44, v87, v12
    v_and_b32 v45, v87, v13
    v_and_b32 v46, v87, v14
    v_and_b32 v47, v87, v15
    v_mfma_f32_16x16x32_bf16 v[32:35], v[40:43], v[184:187], v[32:35]
    s_nop 0
    v_mfma_f32_16x16x32_bf16 v[32:35], v[44:47], v[188:191], v[32:35]
    s_mov_b32 exec_hi, 0
    s_nop 6
    global_store_dwordx4 v58, v[32:35], s[76:77]
    s_mov_b32 exec_hi, -1
    s_add_u32 s76, s76, 114688
    s_addc_u32 s77, s77, 0
    v_and_b32 v40, v88, v12
    v_and_b32 v41, v88, v13
    v_and_b32 v42, v88, v14
    v_and_b32 v43, v88, v15
    v_and_b32 v44, v89, v12
    v_and_b32 v45, v89, v13
    v_and_b32 v46, v89, v14
    v_and_b32 v47, v89, v15
    v_mfma_f32_16x16x32_bf16 v[36:39], v[40:43], v[160:163], 0
    v_and_b32 v40, v90, v12
    v_and_b32 v41, v90, v13
    v_and_b32 v42, v90, v14
    v_and_b32 v43, v90, v15
    v_mfma_f32_16x16x32_bf16 v[36:39], v[44:47], v[164:167], v[36:39]
    v_and_b32 v44, v91, v12
    v_and_b32 v45, v91, v13
    v_and_b32 v46, v91, v14
    v_and_b32 v47, v91, v15
    v_mfma_f32_16x16x32_bf16 v[36:39], v[40:43], v[168:171], v[36:39]
    v_and_b32 v40, v92, v12
    v_and_b32 v41, v92, v13
    v_and_b32 v42, v92, v14
    v_and_b32 v43, v92, v15
    v_mfma_f32_16x16x32_bf16 v[36:39], v[44:47], v[172:175], v[36:39]
    v_and_b32 v44, v93, v12
    v_and_b32 v45, v93, v13
    v_and_b32 v46, v93, v14
    v_and_b32 v47, v93, v15
    v_mfma_f32_16x16x32_bf16 v[36:39], v[40:43], v[176:179], v[36:39]
    v_and_b32 v40, v94, v12
    v_and_b32 v41, v94, v13
    v_and_b32 v42, v94, v14
    v_and_b32 v43, v94, v15
    v_mfma_f32_16x16x32_bf16 v[36:39], v[44:47], v[180:183], v[36:39]
    v_and_b32 v44, v95, v12
    v_and_b32 v45, v95, v13
    v_and_b32 v46, v95, v14
    v_and_b32 v47, v95, v15
    v_mfma_f32_16x16x32_bf16 v[36:39], v[40:43], v[184:187], v[36:39]
    s_nop 0
    v_mfma_f32_16x16x32_bf16 v[36:39], v[44:47], v[188:191], v[36:39]
    s_mov_b32 exec_hi, 0
    s_nop 6
    global_store_dwordx4 v58, v[36:39], s[76:77]
    s_mov_b32 exec_hi, -1
    s_branch L_fin
L_old:
    s_and_b32 s60, s36, 63
    s_or_b32 s60, s60, s3
    s_cmp_lg_u32 s60, 0
    s_cbranch_scc1 L_nogate
    v_lshlrev_b32 v52, 4, v1
    global_load_dwordx4 v[32:35], v52, s[4:5]
    global_load_dwordx4 v[36:39], v52, s[24:25]
    s_waitcnt vmcnt(0)
    v_mov_b32 v11, 0
    v_dot2c_f32_bf16 v11, v32, v36
    v_dot2c_f32_bf16 v11, v33, v37
    v_dot2c_f32_bf16 v11, v34, v38
    v_dot2c_f32_bf16 v11, v35, v39
    s_nop 2
    v_add_f32_dpp v11, v11, v11 quad_perm:[1,0,3,2] row_mask:0xf bank_mask:0xf
    s_nop 1
    v_add_f32_dpp v11, v11, v11 quad_perm:[2,3,0,1] row_mask:0xf bank_mask:0xf
    s_nop 1
    v_add_f32_dpp v11, v11, v11 row_half_mirror row_mask:0xf bank_mask:0xf
    s_nop 1
    v_add_f32_dpp v11, v11, v11 row_mirror row_mask:0xf bank_mask:0xf
    s_nop 0
    v_readlane_b32 s60, v11, 0
    v_readlane_b32 s61, v11, 16
    v_readlane_b32 s62, v11, 32
    v_readlane_b32 s63, v11, 48
    v_mov_b32 v11, s60
    v_add_f32 v11, s61, v11
    v_add_f32 v11, s62, v11
    v_add_f32 v11, s63, v11
    v_mul_f32 v11, 0xbfb8aa3b, v11
    v_exp_f32 v11, v11
    s_nop 0
    v_add_f32 v11, 1.0, v11
    v_rcp_f32 v11, v11
    s_nop 0
    v_readfirstlane_b32 s40, v11
L_nogate:
    s_lshl_b32 s60, s3, 10
    v_lshl_add_u32 v52, v1, 4, s60
    global_load_dwordx4 v[32:35], v52, s[78:79]
    s_waitcnt vmcnt(0)
    ds_write_b128 v52, v[32:35] offset:21760
    s_waitcnt lgkmcnt(0)
    v_mov_b32 v53, 12416
L_worel:
    ds_read_b32 v54, v53 offset:4
    s_waitcnt lgkmcnt(0)
    v_readfirstlane_b32 s60, v54
    s_cmp_eq_u32 s60, 0
    s_cbranch_scc1 L_worel
    s_mov_b32 s68, 0
    buffer_load_dwordx4 v[64:67], v60, s[56:59], s68 offen offset:0
    buffer_load_dwordx4 v[68:71], v60, s[56:59], s68 offen offset:1024
    buffer_load_dwordx4 v[72:75], v60, s[56:59], s68 offen offset:2048
    buffer_load_dwordx4 v[76:79], v60, s[56:59], s68 offen offset:3072
    s_add_u32 s68, s68, 16384
    buffer_load_dwordx4 v[80:83], v60, s[56:59], s68 offen offset:0
    buffer_load_dwordx4 v[84:87], v60, s[56:59], s68 offen offset:1024
    buffer_load_dwordx4 v[88:91], v60, s[56:59], s68 offen offset:2048
    buffer_load_dwordx4 v[92:95], v60, s[56:59], s68 offen offset:3072
    s_add_u32 s68, s68, 16384
    buffer_load_dwordx4 v[96:99], v60, s[56:59], s68 offen offset:0
    buffer_load_dwordx4 v[100:103], v60, s[56:59], s68 offen offset:1024
    buffer_load_dwordx4 v[104:107], v60, s[56:59], s68 offen offset:2048
    buffer_load_dwordx4 v[108:111], v60, s[56:59], s68 offen offset:3072
    s_add_u32 s68, s68, 16384
    buffer_load_dwordx4 v[112:115], v60, s[56:59], s68 offen offset:0
    buffer_load_dwordx4 v[116:119], v60, s[56:59], s68 offen offset:1024
    buffer_load_dwordx4 v[120:123], v60, s[56:59], s68 offen offset:2048
    buffer_load_dwordx4 v[124:127], v60, s[56:59], s68 offen offset:3072
    s_add_u32 s68, s68, 16384
    buffer_load_dwordx4 v[128:131], v60, s[56:59], s68 offen offset:0
    buffer_load_dwordx4 v[132:135], v60, s[56:59], s68 offen offset:1024
    buffer_load_dwordx4 v[136:139], v60, s[56:59], s68 offen offset:2048
    buffer_load_dwordx4 v[140:143], v60, s[56:59], s68 offen offset:3072
    s_add_u32 s68, s68, 16384
    buffer_load_dwordx4 v[144:147], v60, s[56:59], s68 offen offset:0
    buffer_load_dwordx4 v[148:151], v60, s[56:59], s68 offen offset:1024
    buffer_load_dwordx4 v[152:155], v60, s[56:59], s68 offen offset:2048
    buffer_load_dwordx4 v[156:159], v60, s[56:59], s68 offen offset:3072
    s_add_u32 s68, s68, 16384
    buffer_load_dwordx4 v[160:163], v60, s[56:59], s68 offen offset:0
    buffer_load_dwordx4 v[164:167], v60, s[56:59], s68 offen offset:1024
    buffer_load_dwordx4 v[168:171], v60, s[56:59], s68 offen offset:2048
    buffer_load_dwordx4 v[172:175], v60, s[56:59], s68 offen offset:3072
    s_add_u32 s68, s68, 16384
    buffer_load_dwordx4 v[176:179], v60, s[56:59], s68 offen offset:0
    buffer_load_dwordx4 v[180:183], v60, s[56:59], s68 offen offset:1024
    buffer_load_dwordx4 v[184:187], v60, s[56:59], s68 offen offset:2048
    buffer_load_dwordx4 v[188:191], v60, s[56:59], s68 offen offset:3072
    s_getpc_b64 s[62:63]
L_pc2:
    s_add_u32 s62, s62, final_reduce_kernel-L_pc2
    s_addc_u32 s63, s63, 0
    v_lshlrev_b32 v54, 6, v1
    s_mov_b32 s64, L2_done-final_reduce_kernel
    v_min_u32 v54, s64, v54
    global_load_dword v55, v54, s[62:63]
    s_mov_b32 s98, 1
    s_branch L_epi
L_epi_wait:
    s_mov_b32 s98, 0
    s_waitcnt vmcnt(0) lgkmcnt(0)
    s_barrier
L_epi:
    v_mov_b32 v52, 0
    v_lshlrev_b32 v53, 2, v1
    ds_read_b128 v[16:19], v52 offset:12288
    ds_read_b128 v[20:23], v52 offset:12304
    ds_read_b128 v[24:27], v52 offset:12320
    ds_read_b128 v[28:31], v52 offset:12336
    ds_read2st64_b32 v[192:193], v53 offset0:32 offset1:33
    ds_read2st64_b32 v[194:195], v53 offset0:34 offset1:35
    ds_read2st64_b32 v[196:197], v53 offset0:36 offset1:37
    ds_read2st64_b32 v[198:199], v53 offset0:38 offset1:39
    ds_read2st64_b32 v[200:201], v53 offset0:40 offset1:41
    ds_read2st64_b32 v[202:203], v53 offset0:42 offset1:43
    ds_read2st64_b32 v[204:205], v53 offset0:44 offset1:45
    ds_read2st64_b32 v[206:207], v53 offset0:46 offset1:47
    s_waitcnt lgkmcnt(8)
    v_max3_f32 v7, v16, v18, v20
    v_max3_f32 v7, v7, v22, v24
    v_max3_f32 v7, v7, v26, v28
    v_max_f32 v7, v7, v30
    v_mul_f32 v8, s39, v7
    v_fma_f32 v16, v16, s39, -v8
    v_fma_f32 v18, v18, s39, -v8
    v_fma_f32 v20, v20, s39, -v8
    v_fma_f32 v22, v22, s39, -v8
    v_fma_f32 v24, v24, s39, -v8
    v_fma_f32 v26, v26, s39, -v8
    v_fma_f32 v28, v28, s39, -v8
    v_fma_f32 v30, v30, s39, -v8
    v_exp_f32 v16, v16
    v_exp_f32 v18, v18
    v_exp_f32 v20, v20
    v_exp_f32 v22, v22
    v_exp_f32 v24, v24
    v_exp_f32 v26, v26
    v_exp_f32 v28, v28
    v_exp_f32 v30, v30
    s_waitcnt lgkmcnt(0)
    v_mul_f32 v54, v16, v192
    v_mul_f32 v55, v16, v193
    v_fmac_f32 v54, v18, v194
    v_fmac_f32 v55, v18, v195
    v_fmac_f32 v54, v20, v196
    v_fmac_f32 v55, v20, v197
    v_fmac_f32 v54, v22, v198
    v_fmac_f32 v55, v22, v199
    v_fmac_f32 v54, v24, v200
    v_fmac_f32 v55, v24, v201
    v_fmac_f32 v54, v26, v202
    v_fmac_f32 v55, v26, v203
    v_fmac_f32 v54, v28, v204
    v_fmac_f32 v55, v28, v205
    v_fmac_f32 v54, v30, v206
    v_fmac_f32 v55, v30, v207
    v_cvt_pk_bf16_f32 v54, v54, v54
    v_cvt_pk_bf16_f32 v55, v55, v55
    ds_write2st64_b32 v10, v54, v55 offset0:0 offset1:1
    v_mul_f32 v6, v16, v17
    v_fmac_f32 v6, v18, v19
    v_fmac_f32 v6, v20, v21
    v_fmac_f32 v6, v22, v23
    v_fmac_f32 v6, v24, v25
    v_fmac_f32 v6, v26, v27
    v_fmac_f32 v6, v28, v29
    v_fmac_f32 v6, v30, v31
    s_waitcnt lgkmcnt(0)
    ds_read_b128 v[192:195], v62 offset:0
    ds_read_b128 v[196:199], v62 offset:64
    ds_read_b128 v[200:203], v62 offset:128
    ds_read_b128 v[204:207], v62 offset:192
    ds_read_b128 v[208:211], v62 offset:256
    ds_read_b128 v[212:215], v62 offset:320
    ds_read_b128 v[216:219], v62 offset:384
    ds_read_b128 v[220:223], v62 offset:448
    s_waitcnt lgkmcnt(7)
    v_and_b32 v40, v192, v12
    v_and_b32 v41, v192, v13
    v_and_b32 v42, v192, v14
    v_and_b32 v43, v192, v15
    v_and_b32 v44, v193, v12
    v_and_b32 v45, v193, v13
    v_and_b32 v46, v193, v14
    v_and_b32 v47, v193, v15
    v_mfma_f32_16x16x32_bf16 v[32:35], v[40:43], v[64:67], 0
    v_and_b32 v40, v194, v12
    v_and_b32 v41, v194, v13
    v_and_b32 v42, v194, v14
    v_and_b32 v43, v194, v15
    v_mfma_f32_16x16x32_bf16 v[32:35], v[44:47], v[68:71], v[32:35]
    v_and_b32 v44, v195, v12
    v_and_b32 v45, v195, v13
    v_and_b32 v46, v195, v14
    v_and_b32 v47, v195, v15
    v_mfma_f32_16x16x32_bf16 v[32:35], v[40:43], v[72:75], v[32:35]
    s_waitcnt lgkmcnt(6)
    v_and_b32 v40, v196, v12
    v_and_b32 v41, v196, v13
    v_and_b32 v42, v196, v14
    v_and_b32 v43, v196, v15
    v_mfma_f32_16x16x32_bf16 v[32:35], v[44:47], v[76:79], v[32:35]
    v_and_b32 v44, v197, v12
    v_and_b32 v45, v197, v13
    v_and_b32 v46, v197, v14
    v_and_b32 v47, v197, v15
    v_mfma_f32_16x16x32_bf16 v[32:35], v[40:43], v[80:83], v[32:35]
    v_and_b32 v40, v198, v12
    v_and_b32 v41, v198, v13
    v_and_b32 v42, v198, v14
    v_and_b32 v43, v198, v15
    v_mfma_f32_16x16x32_bf16 v[32:35], v[44:47], v[84:87], v[32:35]
    v_and_b32 v44, v199, v12
    v_and_b32 v45, v199, v13
    v_and_b32 v46, v199, v14
    v_and_b32 v47, v199, v15
    v_mfma_f32_16x16x32_bf16 v[32:35], v[40:43], v[88:91], v[32:35]
    s_waitcnt lgkmcnt(5)
    v_and_b32 v40, v200, v12
    v_and_b32 v41, v200, v13
    v_and_b32 v42, v200, v14
    v_and_b32 v43, v200, v15
    v_mfma_f32_16x16x32_bf16 v[32:35], v[44:47], v[92:95], v[32:35]
    v_and_b32 v44, v201, v12
    v_and_b32 v45, v201, v13
    v_and_b32 v46, v201, v14
    v_and_b32 v47, v201, v15
    v_mfma_f32_16x16x32_bf16 v[32:35], v[40:43], v[96:99], v[32:35]
    v_and_b32 v40, v202, v12
    v_and_b32 v41, v202, v13
    v_and_b32 v42, v202, v14
    v_and_b32 v43, v202, v15
    v_mfma_f32_16x16x32_bf16 v[32:35], v[44:47], v[100:103], v[32:35]
    v_and_b32 v44, v203, v12
    v_and_b32 v45, v203, v13
    v_and_b32 v46, v203, v14
    v_and_b32 v47, v203, v15
    v_mfma_f32_16x16x32_bf16 v[32:35], v[40:43], v[104:107], v[32:35]
    s_waitcnt lgkmcnt(4)
    v_and_b32 v40, v204, v12
    v_and_b32 v41, v204, v13
    v_and_b32 v42, v204, v14
    v_and_b32 v43, v204, v15
    v_mfma_f32_16x16x32_bf16 v[32:35], v[44:47], v[108:111], v[32:35]
    v_and_b32 v44, v205, v12
    v_and_b32 v45, v205, v13
    v_and_b32 v46, v205, v14
    v_and_b32 v47, v205, v15
    v_mfma_f32_16x16x32_bf16 v[32:35], v[40:43], v[112:115], v[32:35]
    v_and_b32 v40, v206, v12
    v_and_b32 v41, v206, v13
    v_and_b32 v42, v206, v14
    v_and_b32 v43, v206, v15
    v_mfma_f32_16x16x32_bf16 v[32:35], v[44:47], v[116:119], v[32:35]
    v_and_b32 v44, v207, v12
    v_and_b32 v45, v207, v13
    v_and_b32 v46, v207, v14
    v_and_b32 v47, v207, v15
    v_mfma_f32_16x16x32_bf16 v[32:35], v[40:43], v[120:123], v[32:35]
    s_waitcnt lgkmcnt(3)
    v_and_b32 v40, v208, v12
    v_and_b32 v41, v208, v13
    v_and_b32 v42, v208, v14
    v_and_b32 v43, v208, v15
    v_mfma_f32_16x16x32_bf16 v[32:35], v[44:47], v[124:127], v[32:35]
    v_and_b32 v44, v209, v12
    v_and_b32 v45, v209, v13
    v_and_b32 v46, v209, v14
    v_and_b32 v47, v209, v15
    v_mfma_f32_16x16x32_bf16 v[32:35], v[40:43], v[128:131], v[32:35]
    v_and_b32 v40, v210, v12
    v_and_b32 v41, v210, v13
    v_and_b32 v42, v210, v14
    v_and_b32 v43, v210, v15
    v_mfma_f32_16x16x32_bf16 v[32:35], v[44:47], v[132:135], v[32:35]
    v_and_b32 v44, v211, v12
    v_and_b32 v45, v211, v13
    v_and_b32 v46, v211, v14
    v_and_b32 v47, v211, v15
    v_mfma_f32_16x16x32_bf16 v[32:35], v[40:43], v[136:139], v[32:35]
    s_waitcnt lgkmcnt(2)
    v_and_b32 v40, v212, v12
    v_and_b32 v41, v212, v13
    v_and_b32 v42, v212, v14
    v_and_b32 v43, v212, v15
    v_mfma_f32_16x16x32_bf16 v[32:35], v[44:47], v[140:143], v[32:35]
    v_and_b32 v44, v213, v12
    v_and_b32 v45, v213, v13
    v_and_b32 v46, v213, v14
    v_and_b32 v47, v213, v15
    v_mfma_f32_16x16x32_bf16 v[32:35], v[40:43], v[144:147], v[32:35]
    v_and_b32 v40, v214, v12
    v_and_b32 v41, v214, v13
    v_and_b32 v42, v214, v14
    v_and_b32 v43, v214, v15
    v_mfma_f32_16x16x32_bf16 v[32:35], v[44:47], v[148:151], v[32:35]
    v_and_b32 v44, v215, v12
    v_and_b32 v45, v215, v13
    v_and_b32 v46, v215, v14
    v_and_b32 v47, v215, v15
    v_mfma_f32_16x16x32_bf16 v[32:35], v[40:43], v[152:155], v[32:35]
    s_waitcnt lgkmcnt(1)
    v_and_b32 v40, v216, v12
    v_and_b32 v41, v216, v13
    v_and_b32 v42, v216, v14
    v_and_b32 v43, v216, v15
    v_mfma_f32_16x16x32_bf16 v[32:35], v[44:47], v[156:159], v[32:35]
    v_and_b32 v44, v217, v12
    v_and_b32 v45, v217, v13
    v_and_b32 v46, v217, v14
    v_and_b32 v47, v217, v15
    v_mfma_f32_16x16x32_bf16 v[32:35], v[40:43], v[160:163], v[32:35]
    v_and_b32 v40, v218, v12
    v_and_b32 v41, v218, v13
    v_and_b32 v42, v218, v14
    v_and_b32 v43, v218, v15
    v_mfma_f32_16x16x32_bf16 v[32:35], v[44:47], v[164:167], v[32:35]
    v_and_b32 v44, v219, v12
    v_and_b32 v45, v219, v13
    v_and_b32 v46, v219, v14
    v_and_b32 v47, v219, v15
    v_mfma_f32_16x16x32_bf16 v[32:35], v[40:43], v[168:171], v[32:35]
    s_waitcnt lgkmcnt(0)
    v_and_b32 v40, v220, v12
    v_and_b32 v41, v220, v13
    v_and_b32 v42, v220, v14
    v_and_b32 v43, v220, v15
    v_mfma_f32_16x16x32_bf16 v[32:35], v[44:47], v[172:175], v[32:35]
    v_and_b32 v44, v221, v12
    v_and_b32 v45, v221, v13
    v_and_b32 v46, v221, v14
    v_and_b32 v47, v221, v15
    v_mfma_f32_16x16x32_bf16 v[32:35], v[40:43], v[176:179], v[32:35]
    v_and_b32 v40, v222, v12
    v_and_b32 v41, v222, v13
    v_and_b32 v42, v222, v14
    v_and_b32 v43, v222, v15
    v_mfma_f32_16x16x32_bf16 v[32:35], v[44:47], v[180:183], v[32:35]
    v_and_b32 v44, v223, v12
    v_and_b32 v45, v223, v13
    v_and_b32 v46, v223, v14
    v_and_b32 v47, v223, v15
    v_mfma_f32_16x16x32_bf16 v[32:35], v[40:43], v[184:187], v[32:35]
    s_nop 0
    v_mfma_f32_16x16x32_bf16 v[32:35], v[44:47], v[188:191], v[32:35]
    s_cmp_lg_u32 s98, 0
    s_cbranch_scc1 L_epi_wait
    s_mov_b32 exec_hi, 0
    s_nop 4
    global_store_dwordx4 v61, v[32:35], s[76:77]
    s_mov_b64 exec, -1
    s_cmp_lg_u32 s3, 0
    s_cbranch_scc1 L_w0done
    v_mov_b32 v54, v8
    v_mov_b32 v55, v6
    v_mov_b32 v56, s40
    v_sub_f32 v57, 1.0, v56
    s_lshl_b32 s62, s36, 3
    s_add_u32 s62, s62, 0x100000
    v_mov_b32 v58, s62
    s_mov_b64 exec, 1
    global_store_dwordx2 v58, v[54:55], s[30:31]
    s_and_b32 s63, s36, 63
    s_cmp_lg_u32 s63, 0
    s_cbranch_scc1 L_nog
    s_lshl_b32 s62, s33, 3
    s_add_u32 s62, s62, 0x101000
    v_mov_b32 v59, s62
    global_store_dwordx2 v59, v[56:57], s[30:31]
L_nog:
    s_mov_b64 exec, -1
L_w0done:
L_fin:
L_done:
    s_endpgm
L_tr0:
    s_swappc_b64 s[72:73], s[74:75]
    s_branch L_back0
L_tr1:
    s_swappc_b64 s[72:73], s[74:75]
    s_branch L_back1
L_tr2:
    s_swappc_b64 s[72:73], s[74:75]
    s_branch L_back2
L_tr3:
    s_swappc_b64 s[72:73], s[74:75]
    s_branch L_back3
L_rare:
    v_readlane_b32 s60, v52, 0
    v_readlane_b32 s61, v52, 16
    v_readlane_b32 s62, v52, 32
    v_readlane_b32 s63, v52, 48
    v_mov_b32 v53, s60
    v_max_f32 v53, s61, v53
    v_max_f32 v53, s62, v53
    v_max_f32 v53, s63, v53
    v_max_f32 v53, v53, v7
    v_sub_f32 v54, v7, v53
    v_mul_f32 v54, s39, v54
    v_exp_f32 v54, v54
    v_mov_b32 v7, v53
    v_mul_f32 v8, s39, v53
    v_mul_f32 v48, v48, v54
    v_mul_f32 v49, v49, v54
    v_mul_f32 v50, v50, v54
    v_mul_f32 v51, v51, v54
    v_mul_f32 v6, v6, v54
    s_nop 1
    s_setpc_b64 s[72:73]
.globl final_reduce_kernel
.p2align 8
.type final_reduce_kernel,@function
final_reduce_kernel:
    s_cmp_ge_u32 s2, 64
    s_cbranch_scc1 L2_done
    s_load_dwordx2 s[4:5], s[0:1], 88
    s_load_dwordx2 s[6:7], s[0:1], 104
    s_load_dwordx2 s[32:33], s[0:1], 72
    s_lshr_b32 s8, s2, 4
    s_and_b32 s9, s2, 15
    v_lshrrev_b32 v1, 3, v0
    v_and_b32 v2, 7, v0
    v_lshlrev_b32 v3, 14, v1
    v_lshl_add_u32 v3, v2, 4, v3
    v_lshlrev_b32 v4, 11, v1
    v_lshl_add_u32 v4, v2, 4, v4
    v_lshlrev_b32 v5, 6, v1
    v_lshlrev_b32 v6, 3, v2
    s_lshl_b32 s10, s8, 17
    s_lshl_b32 s11, s9, 7
    s_add_u32 s10, s10, s11
    s_mul_i32 s12, s8, 114688
    s_add_u32 s12, s12, s11
    s_add_u32 s12, s12, 0x80000
    s_lshl_b32 s13, s8, 9
    s_add_u32 s13, s13, 0x100000
    s_movk_i32 s24, 4096
    s_movk_i32 s25, 8192
    s_movk_i32 s26, 12288
    s_mov_b32 s42, 16384
    s_mov_b32 s43, 32768
    s_mov_b32 s44, 49152
    s_mov_b32 s45, 65536
    s_mov_b32 s46, 81920
    s_mov_b32 s47, 98304
    s_lshl_b32 s31, s8, 3
    s_add_u32 s31, s31, 0x101000
    v_mov_b32 v7, s31
    s_lshl_b32 s35, s9, 6
    s_waitcnt lgkmcnt(0)
    s_add_u32 s14, s6, s13
    s_addc_u32 s15, s7, 0
    global_load_dwordx4 v[8:11], v5, s[14:15] offset:0
    global_load_dwordx4 v[12:15], v5, s[14:15] offset:16
    global_load_dwordx4 v[16:19], v5, s[14:15] offset:32
    global_load_dwordx4 v[20:23], v5, s[14:15] offset:48
    s_add_u32 s16, s6, s10
    s_addc_u32 s17, s7, 0
    s_mov_b32 s18, 0x20000
    s_mov_b32 s19, 0x20000
    buffer_load_dwordx4 v[24:27], v3, s[16:19], 0 offen offset:0
    buffer_load_dwordx4 v[28:31], v3, s[16:19], 0 offen offset:2048
    buffer_load_dwordx4 v[32:35], v3, s[16:19], s24 offen offset:0
    buffer_load_dwordx4 v[36:39], v3, s[16:19], s24 offen offset:2048
    buffer_load_dwordx4 v[40:43], v3, s[16:19], s25 offen offset:0
    buffer_load_dwordx4 v[44:47], v3, s[16:19], s25 offen offset:2048
    buffer_load_dwordx4 v[48:51], v3, s[16:19], s26 offen offset:0
    buffer_load_dwordx4 v[52:55], v3, s[16:19], s26 offen offset:2048
    s_add_u32 s20, s6, s12
    s_addc_u32 s21, s7, 0
    s_sub_u32 s22, 114688, s11
    s_mov_b32 s23, 0x20000
    buffer_load_dwordx4 v[88:91], v4, s[20:23], 0 offen
    buffer_load_dwordx4 v[92:95], v4, s[20:23], s42 offen
    buffer_load_dwordx4 v[96:99], v4, s[20:23], s43 offen
    buffer_load_dwordx4 v[100:103], v4, s[20:23], s44 offen
    buffer_load_dwordx4 v[104:107], v4, s[20:23], s45 offen
    buffer_load_dwordx4 v[108:111], v4, s[20:23], s46 offen
    buffer_load_dwordx4 v[112:115], v4, s[20:23], s47 offen
    global_load_dwordx2 v[72:73], v7, s[6:7]
    s_add_u32 s32, s32, s35
    s_addc_u32 s33, s33, 0
    global_load_dwordx2 v[74:75], v6, s[32:33]
    s_lshl_b32 s34, s8, 10
    s_add_u32 s34, s34, s35
    s_add_u32 s4, s4, s34
    s_addc_u32 s5, s5, 0
    s_waitcnt vmcnt(17)
    v_max_f32 v84, v8, v10
    v_sub_f32 v8, v8, v84
    v_sub_f32 v10, v10, v84
    v_exp_f32 v8, v8
    v_exp_f32 v10, v10
    v_mul_f32 v9, v9, v8
    v_fmac_f32 v9, v11, v10
    v_rcp_f32 v9, v9
    s_nop 0
    v_mul_f32 v8, v8, v9
    v_mul_f32 v10, v10, v9
    v_max_f32 v84, v12, v14
    v_sub_f32 v12, v12, v84
    v_sub_f32 v14, v14, v84
    v_exp_f32 v12, v12
    v_exp_f32 v14, v14
    v_mul_f32 v13, v13, v12
    v_fmac_f32 v13, v15, v14
    v_rcp_f32 v13, v13
    s_nop 0
    v_mul_f32 v12, v12, v13
    v_mul_f32 v14, v14, v13
    v_max_f32 v84, v16, v18
    v_sub_f32 v16, v16, v84
    v_sub_f32 v18, v18, v84
    v_exp_f32 v16, v16
    v_exp_f32 v18, v18
    v_mul_f32 v17, v17, v16
    v_fmac_f32 v17, v19, v18
    v_rcp_f32 v17, v17
    s_nop 0
    v_mul_f32 v16, v16, v17
    v_mul_f32 v18, v18, v17
    v_max_f32 v84, v20, v22
    v_sub_f32 v20, v20, v84
    v_sub_f32 v22, v22, v84
    v_exp_f32 v20, v20
    v_exp_f32 v22, v22
    v_mul_f32 v21, v21, v20
    v_fmac_f32 v21, v23, v22
    v_rcp_f32 v21, v21
    s_nop 0
    v_mul_f32 v20, v20, v21
    v_mul_f32 v22, v22, v21
    s_waitcnt vmcnt(9)
    v_mul_f32 v84, v8, v24
    v_mul_f32 v85, v8, v25
    v_mul_f32 v86, v8, v26
    v_mul_f32 v87, v8, v27
    v_fmac_f32 v84, v10, v28
    v_fmac_f32 v85, v10, v29
    v_fmac_f32 v86, v10, v30
    v_fmac_f32 v87, v10, v31
    v_fmac_f32 v84, v12, v32
    v_fmac_f32 v85, v12, v33
    v_fmac_f32 v86, v12, v34
    v_fmac_f32 v87, v12, v35
    v_fmac_f32 v84, v14, v36
    v_fmac_f32 v85, v14, v37
    v_fmac_f32 v86, v14, v38
    v_fmac_f32 v87, v14, v39
    v_fmac_f32 v84, v16, v40
    v_fmac_f32 v85, v16, v41
    v_fmac_f32 v86, v16, v42
    v_fmac_f32 v87, v16, v43
    v_fmac_f32 v84, v18, v44
    v_fmac_f32 v85, v18, v45
    v_fmac_f32 v86, v18, v46
    v_fmac_f32 v87, v18, v47
    v_fmac_f32 v84, v20, v48
    v_fmac_f32 v85, v20, v49
    v_fmac_f32 v86, v20, v50
    v_fmac_f32 v87, v20, v51
    v_fmac_f32 v84, v22, v52
    v_fmac_f32 v85, v22, v53
    v_fmac_f32 v86, v22, v54
    v_fmac_f32 v87, v22, v55
    s_waitcnt vmcnt(0)
    v_add_f32 v56, v88, v92
    v_add_f32 v57, v89, v93
    v_add_f32 v58, v90, v94
    v_add_f32 v59, v91, v95
    v_add_f32 v56, v56, v96
    v_add_f32 v57, v57, v97
    v_add_f32 v58, v58, v98
    v_add_f32 v59, v59, v99
    v_add_f32 v56, v56, v100
    v_add_f32 v57, v57, v101
    v_add_f32 v58, v58, v102
    v_add_f32 v59, v59, v103
    v_add_f32 v56, v56, v104
    v_add_f32 v57, v57, v105
    v_add_f32 v58, v58, v106
    v_add_f32 v59, v59, v107
    v_add_f32 v56, v56, v108
    v_add_f32 v57, v57, v109
    v_add_f32 v58, v58, v110
    v_add_f32 v59, v59, v111
    v_add_f32 v56, v56, v112
    v_add_f32 v57, v57, v113
    v_add_f32 v58, v58, v114
    v_add_f32 v59, v59, v115
    v_lshlrev_b32 v76, 16, v74
    v_and_b32 v77, 0xffff0000, v74
    v_lshlrev_b32 v78, 16, v75
    v_and_b32 v79, 0xffff0000, v75
    v_cmp_eq_u32 vcc, 0, v1
    s_nop 1
    v_cndmask_b32 v76, 0, v76, vcc
    v_cndmask_b32 v77, 0, v77, vcc
    v_cndmask_b32 v78, 0, v78, vcc
    v_cndmask_b32 v79, 0, v79, vcc
    v_add_f32 v56, v56, v76
    v_add_f32 v57, v57, v77
    v_add_f32 v58, v58, v78
    v_add_f32 v59, v59, v79
    v_mul_f32 v84, v72, v84
    v_mul_f32 v85, v72, v85
    v_mul_f32 v86, v72, v86
    v_mul_f32 v87, v72, v87
    v_fmac_f32 v84, v73, v56
    v_fmac_f32 v85, v73, v57
    v_fmac_f32 v86, v73, v58
    v_fmac_f32 v87, v73, v59
    v_add_f32_dpp v84, v84, v84 row_ror:8 row_mask:0xf bank_mask:0xf
    v_add_f32_dpp v85, v85, v85 row_ror:8 row_mask:0xf bank_mask:0xf
    v_add_f32_dpp v86, v86, v86 row_ror:8 row_mask:0xf bank_mask:0xf
    v_add_f32_dpp v87, v87, v87 row_ror:8 row_mask:0xf bank_mask:0xf
    v_mov_b32 v60, v84
    v_mov_b32 v61, v85
    v_mov_b32 v62, v86
    v_mov_b32 v63, v87
    v_permlane16_swap_b32 v84, v60
    v_permlane16_swap_b32 v85, v61
    v_permlane16_swap_b32 v86, v62
    v_permlane16_swap_b32 v87, v63
    v_add_f32 v84, v84, v60
    v_add_f32 v85, v85, v61
    v_add_f32 v86, v86, v62
    v_add_f32 v87, v87, v63
    v_mov_b32 v60, v84
    v_mov_b32 v61, v85
    v_mov_b32 v62, v86
    v_mov_b32 v63, v87
    v_permlane32_swap_b32 v84, v60
    v_permlane32_swap_b32 v85, v61
    v_permlane32_swap_b32 v86, v62
    v_permlane32_swap_b32 v87, v63
    v_add_f32 v84, v84, v60
    v_add_f32 v85, v85, v61
    v_add_f32 v86, v86, v62
    v_add_f32 v87, v87, v63
    v_cvt_pk_bf16_f32 v84, v84, v85
    v_cvt_pk_bf16_f32 v85, v86, v87
    s_mov_b64 exec, 0xff
    global_store_dwordx2 v6, v[84:85], s[4:5]
L2_done:
    s_endpgm
.section .rodata,"a"
.p2align 6
.amdhsa_kernel gated_mix__mha_block_cached__dense_activation_squared_relu__decode_kernel
  .amdhsa_next_free_vgpr 224
  .amdhsa_next_free_sgpr 100
  .amdhsa_accum_offset 224
  .amdhsa_group_segment_fixed_size 0
  .amdhsa_kernarg_size 112
  .amdhsa_user_sgpr_count 2
  .amdhsa_user_sgpr_kernarg_segment_ptr 1
  .amdhsa_system_sgpr_workgroup_id_x 1
  .amdhsa_float_denorm_mode_32 3
.end_amdhsa_kernel
.p2align 6
.amdhsa_kernel final_reduce_kernel
  .amdhsa_next_free_vgpr 116
  .amdhsa_next_free_sgpr 56
  .amdhsa_accum_offset 116
  .amdhsa_group_segment_fixed_size 0
  .amdhsa_kernarg_size 112
  .amdhsa_user_sgpr_count 2
  .amdhsa_user_sgpr_kernarg_segment_ptr 1
  .amdhsa_system_sgpr_workgroup_id_x 1
  .amdhsa_float_denorm_mode_32 3
.end_amdhsa_kernel
```
